```python
import torch

def _softmax(x, axis=-1):
    return torch.softmax(x, dim=axis)
def _gelu(x):
    return torch.nn.functional.gelu(x, approximate="tanh")
def _silu(x):
    return torch.nn.functional.silu(x)
def _sigmoid(x):
    return torch.sigmoid(x)
def _layernorm(x, axis=-1, eps=1e-5):
    m = x.mean(dim=axis, keepdim=True)
    v = x.var(dim=axis, keepdim=True, unbiased=False)
    return (x - m) / torch.sqrt(v + eps)
def _scatter_add(tgt, idx, src, axis=0):
    return tgt.clone().index_add_(axis, idx, src)
def _segment_sum(src, seg, n):
    out = torch.zeros((n,) + src.shape[1:], dtype=src.dtype)
    return out.index_add_(0, seg, src)
def _pad(x, pw):
    flat = tuple(v for pair in reversed(pw) for v in pair)
    return torch.nn.functional.pad(x, flat)

kernel_name = 'parallel_sum__ssm_conv_h3__dense_activation_relu__prompt'

def setup_inputs():

    _w = (lambda a: (lambda t: t.to(torch.bfloat16) if t.is_floating_point() else t)(torch.as_tensor(a)))
    def _A_setup():
        B, S, D = 1, 2048, 448
        ks = 4
        return {
            "q": _w((lambda *s: torch.randn(*s, dtype=torch.bfloat16) * 0.05)(B, S, D)),
            "k": _w((lambda *s: torch.randn(*s, dtype=torch.bfloat16) * 0.8)(B, S, D)),
            "v": _w((lambda *s: torch.randn(*s, dtype=torch.bfloat16) * 0.8)(B, S, D)),
            "shift_k": _w((lambda *s: torch.randn(*s, dtype=torch.bfloat16) * 0.8)(D, ks) * 0.5),
            "ssm_k": _w((lambda *s: torch.randn(*s, dtype=torch.bfloat16) * 0.8)(D, S) * (1.0 / S ** 0.5)),
            "ssm_D": _w((lambda *s: torch.randn(*s, dtype=torch.bfloat16) * 0.8)(D)),
        }
    _A_in = _A_setup()

    def _B_setup():
        B, S, D, Dff = 1, 2048, 448, 1792
        return {
            "x": _w((lambda *s: torch.randn(*s, dtype=torch.bfloat16) * 0.05)(B, S, D)),
            "w1": _w((lambda *s: torch.randn(*s, dtype=torch.bfloat16) * 0.05)(D, Dff)),
            "w2": _w((lambda *s: torch.randn(*s, dtype=torch.bfloat16) * 0.05)(Dff, D)),
        }
    _B_in = _B_setup()

    return {
        "A_q": _A_in["q"],
        "A_k": _A_in["k"],
        "A_v": _A_in["v"],
        "A_shift_k": _A_in["shift_k"],
        "A_ssm_k": _A_in["ssm_k"],
        "A_ssm_D": _A_in["ssm_D"],
        "B_x": _B_in["x"],
        "B_w1": _B_in["w1"],
        "B_w2": _B_in["w2"],
    }

def reference(A_q, A_k, A_v, A_shift_k, A_ssm_k, A_ssm_D, B_x, B_w1, B_w2):
    def _A_ref(q, k, v, shift_k, ssm_k, ssm_D):
        B, S, D = q.shape
        ks = shift_k.shape[-1]
        k_pad = _pad(k, ((0, 0), (ks - 1, 0), (0, 0)))
        k_shift = torch.zeros_like(k)
        for t in range(ks):
            k_shift = k_shift + k_pad[:, t:t + S, :] * shift_k[:, ks - 1 - t][None, None, :]
        kv = k_shift * v
        L = 2 * S
        kv_pad = _pad(kv, ((0, 0), (0, S), (0, 0)))
        kf_pad = _pad(ssm_k, ((0, 0), (0, S)))
        kv_f = (lambda x, axes=(-2,-1): torch.fft.rfft2(x.float(), dim=axes))(kv_pad[:, None, :, :], axes=(1, 2))
        kf_f = (lambda x, axes=(-2,-1): torch.fft.rfft2(x.float(), dim=axes))(kf_pad[:, None, :], axes=(1, 2))
        kf_f = (lambda x, *d: x.permute(*d))(kf_f, 1, 2, 0)
        y_f = kv_f * kf_f[None, :, :, :]
        y = (lambda x, s, axes=(-2,-1): torch.fft.irfft2(x, s=s, dim=axes).to(torch.bfloat16))(y_f, (1, L), axes=(1, 2))[:, 0, :S, :]
        y = y + kv * ssm_D[None, None, :]
        return q * y

    def _B_ref(x, w1, w2):
        h = torch.einsum("bsd,df->bsf", x, w1)
        zero = torch.zeros_like(h)
        h = torch.maximum(h, zero)
        return torch.einsum("bsf,fd->bsd", h, w2)

    x = A_q
    xn = _layernorm(x, axis=-1)
    return x + _A_ref(xn, A_k, A_v, A_shift_k, A_ssm_k, A_ssm_D) + _B_ref(xn, B_w1, B_w2)
```

```asm
; @launch grid=(256,1,1) block=(512,1,1) lds=163840
.amdgcn_target "amdgcn-amd-amdhsa--gfx950"
.text
.globl parallel_sum__ssm_conv_h3__dense_activation_relu__prompt_kernel
.p2align 8
.type parallel_sum__ssm_conv_h3__dense_activation_relu__prompt_kernel,@function
parallel_sum__ssm_conv_h3__dense_activation_relu__prompt_kernel:
    s_load_dwordx16 s[4:19], s[0:1], 0
    s_load_dwordx8 s[20:27], s[0:1], 64
    s_cmp_ge_u32 s2, 256
    s_cbranch_scc1 L_end
    s_lshr_b32 s81, s2, 3
    v_lshrrev_b32 v2, 6, v0
    s_getpc_b64 s[84:85]
    v_readfirstlane_b32 s83, v2
    s_mul_i32 s80, s81, 768
    v_and_b32 v1, 63, v0
    s_cmp_lg_u32 s83, 0
    s_cbranch_scc1 CP_1
    v_lshl_add_u32 v3, v1, 7, s80
    s_mov_b64 exec, 63
    global_load_dword v255, v3, s[84:85]
    s_mov_b64 exec, -1
CP_1:
    s_and_b32 s79, s2, 7
    s_cmp_ge_u32 s2, 224
    s_cbranch_scc1 L_helper
    s_and_b32 s60, s83, 3
    s_mul_i32 s62, s81, 37
    s_lshr_b32 s62, s62, 8
    s_mul_i32 s82, s62, 7
    s_sub_u32 s61, s81, s82
    s_and_b32 s63, s79, 1
    s_lshr_b32 s81, s79, 1
    s_lshl2_add_u32 s64, s81, s62
    s_lshl1_add_u32 s69, s64, s63
    s_lshl_b32 s64, s64, 7
    s_lshl_b32 s66, s69, 6
    s_mul_i32 s65, s63, 7
    s_add_u32 s65, s65, s61
    s_lshl_b32 s65, s65, 7
    s_lshl_b32 s67, s61, 6
    s_lshl_b32 s75, s60, 15
    s_cmp_lt_u32 s83, 4
    s_cbranch_scc1 L_A
    v_lshrrev_b32 v16, 4, v1
    v_lshrrev_b32 v17, 3, v1
    v_mul_u32_u24 v17, 896, v17
    v_and_b32 v18, 7, v1
    v_xor_b32 v18, v18, v16
    v_lshl_add_u32 v12, v18, 4, v17
    v_xor_b32 v17, 64, v12
    v_add_u32 v13, 6144, v17
    v_add_u32 v14, 12288, v12
    v_add_u32 v15, 18432, v17
    v_lshlrev_b32 v17, 1, v16
    v_and_b32 v18, 15, v1
    v_xor_b32 v17, v17, v18
    v_mul_u32_u24 v19, 3584, v16
    v_lshl_add_u32 v20, v17, 4, v19
    v_xor_b32 v17, 128, v20
    v_add_u32 v21, 13312, v20
    v_add_u32 v22, 26624, v17
    v_add_u32 v23, 39936, v17
    s_lshl_b32 s80, s60, 5
    s_add_u32 s80, s80, s64
    s_mul_i32 s85, s80, 896
    s_mul_i32 s86, s60, 57344
    s_lshl1_add_u32 s86, s65, s86
    s_lshl4_add_u32 s80, s60, s66
    s_mul_i32 s84, s80, 896
    s_lshl1_add_u32 s84, s67, s84
    s_sub_u32 s81, s84, 7168
    v_add_u32 v24, s81, v12
    s_mov_b32 s30, 1835008
    s_mov_b32 s31, 0x20000
    s_mov_b32 s46, 1605632
    s_mov_b32 s47, 0x20000
    s_mov_b32 s34, 1835008
    s_mov_b32 s35, 0x20000
    s_mov_b32 s38, 1835008
    s_mov_b32 s39, 0x20000
    s_waitcnt lgkmcnt(0)
    s_add_u32 m0, s75, 0
    s_mov_b32 s28, s4
    s_and_b32 s29, s5, 0xffff
    buffer_load_dwordx4 v12, s[28:31], s85 offen lds
    buffer_load_dwordx4 v13, s[28:31], s85 offen offset:1024 lds
    buffer_load_dwordx4 v14, s[28:31], s85 offen offset:2048 lds
    buffer_load_dwordx4 v15, s[28:31], s85 offen offset:3072 lds
    s_add_u32 m0, s75, 4096
    s_mov_b32 s44, s18
    s_and_b32 s45, s19, 0xffff
    buffer_load_dwordx4 v20, s[44:47], s86 offen lds
    buffer_load_dwordx4 v21, s[44:47], s86 offen offset:1024 lds
    buffer_load_dwordx4 v22, s[44:47], s86 offen offset:2048 lds
    buffer_load_dwordx4 v23, s[44:47], s86 offen offset:3072 lds
    s_add_u32 m0, s75, 8192
    s_add_u32 s85, s85, 128
    buffer_load_dwordx4 v12, s[28:31], s85 offen lds
    buffer_load_dwordx4 v13, s[28:31], s85 offen offset:1024 lds
    buffer_load_dwordx4 v14, s[28:31], s85 offen offset:2048 lds
    buffer_load_dwordx4 v15, s[28:31], s85 offen offset:3072 lds
    s_add_u32 m0, s75, 12288
    s_add_u32 s86, s86, 229376
    buffer_load_dwordx4 v20, s[44:47], s86 offen lds
    buffer_load_dwordx4 v21, s[44:47], s86 offen offset:1024 lds
    buffer_load_dwordx4 v22, s[44:47], s86 offen offset:2048 lds
    buffer_load_dwordx4 v23, s[44:47], s86 offen offset:3072 lds
    s_mov_b32 s32, s6
    s_and_b32 s33, s7, 0xffff
    s_mov_b32 s36, s8
    s_and_b32 s37, s9, 0xffff
    s_lshl_b32 s73, s69, 12
    s_add_u32 s73, s73, 524288
    s_lshl2_add_u32 s68, s79, s62
    s_lshl_b32 s72, s61, 16
    s_and_b32 s77, s60, 1
    s_lshr_b32 s78, s60, 1
    s_lshl1_add_u32 s76, s68, s67
    s_add_u32 s76, s76, s78
    s_waitcnt lgkmcnt(0)
    s_load_dword s70, s[26:27], s72
    s_load_dword s71, s[26:27], s73
    s_mov_b32 s40, s12
    s_and_b32 s41, s13, 0xffff
    s_mov_b32 s42, 1835008
    s_mov_b32 s43, 0x20000
    s_mov_b32 s48, s20
    s_and_b32 s49, s21, 0xffff
    s_mov_b32 s50, 1605632
    s_mov_b32 s51, 0x20000
    s_mov_b32 s56, s26
    s_and_b32 s57, s27, 0xffff
    s_mov_b32 s58, 20971520
    s_mov_b32 s59, 0x20000
    v_add_u32 v4, 0, v12
    v_add_u32 v5, 6144, v12
    v_add_u32 v6, 12288, v12
    v_add_u32 v7, 18432, v12
    v_bfe_u32 v17, v1, 2, 2
    v_and_b32 v18, 1, v16
    v_lshl_add_u32 v17, v18, 2, v17
    v_lshrrev_b32 v18, 1, v17
    v_lshrrev_b32 v19, 1, v16
    v_lshl_add_u32 v17, v19, 3, v17
    v_bfe_u32 v19, v1, 1, 1
    v_lshl_add_u32 v18, v19, 2, v18
    v_lshlrev_b32 v18, 4, v18
    v_lshl_add_u32 v17, v17, 7, v18
    v_and_b32 v18, 1, v1
    v_lshl_add_u32 v17, v18, 3, v17
    v_add_u32 v8, s75, v17
    v_xor_b32 v9, 16, v8
    v_xor_b32 v10, 32, v8
    v_xor_b32 v11, 48, v8
    v_lshlrev_b32 v26, 6, v1
    v_lshlrev_b32 v1, 4, v1
    s_lshl_b32 s80, s61, 2
    s_lshr_b32 s80, 5517840, s80
    s_and_b32 s80, s80, 15
    s_lshl_b32 s81, s62, 2
    s_lshr_b32 s81, 0, s81
    s_and_b32 s81, s81, 15
    s_add_u32 s80, s80, s81
    s_lshl_b32 s81, s79, 2
    s_lshr_b32 s81, 0, s81
    s_and_b32 s81, s81, 15
    s_add_u32 s80, s80, s81
    s_cmp_ge_u32 s80, 6
    s_cselect_b32 s81, 6, 0
    s_sub_u32 s80, s80, s81
    s_cmp_ge_u32 s80, 6
    s_cselect_b32 s81, 6, 0
    s_sub_u32 s80, s80, s81
    s_mul_i32 s81, s60, 24576
    s_mul_i32 s82, s63, 114688
    s_add_u32 s81, s81, s82
    s_lshl_b32 s80, s80, 12
    s_add_u32 s80, s80, s81
    s_add_u32 s82, s81, 24576
    s_lshl_b32 s91, s65, 7
    s_cmp_ge_u32 s80, s91
    s_cselect_b32 s4, 16384, 0
    s_add_u32 s4, s4, s80
    s_add_u32 s80, s80, 4096
    s_cmp_eq_u32 s80, s82
    s_cselect_b32 s80, s81, s80
    s_cmp_ge_u32 s80, s91
    s_cselect_b32 s5, 16384, 0
    s_add_u32 s5, s5, s80
    s_add_u32 s80, s80, 4096
    s_cmp_eq_u32 s80, s82
    s_cselect_b32 s80, s81, s80
    s_cmp_ge_u32 s80, s91
    s_cselect_b32 s6, 16384, 0
    s_add_u32 s6, s6, s80
    s_add_u32 s80, s80, 4096
    s_cmp_eq_u32 s80, s82
    s_cselect_b32 s80, s81, s80
    s_cmp_ge_u32 s80, s91
    s_cselect_b32 s7, 16384, 0
    s_add_u32 s7, s7, s80
    s_add_u32 s80, s80, 4096
    s_cmp_eq_u32 s80, s82
    s_cselect_b32 s80, s81, s80
    s_cmp_ge_u32 s80, s91
    s_cselect_b32 s8, 16384, 0
    s_add_u32 s8, s8, s80
    s_add_u32 s80, s80, 4096
    s_cmp_eq_u32 s80, s82
    s_cselect_b32 s80, s81, s80
    s_cmp_ge_u32 s80, s91
    s_cselect_b32 s9, 16384, 0
    s_add_u32 s9, s9, s80
    s_mul_i32 s80, s60, 384
    s_add_u32 s80, s80, s73
    s_add_u32 s90, s80, 128
    s_lshl_b32 s80, s60, 12
    s_add_u32 s91, s91, s80
    s_lshl_b32 s92, s67, 1
    s_xor_b32 s80, s69, 1
    s_mul_i32 s95, s80, 229376
    s_mul_i32 s96, s69, 229376
    s_sub_u32 s96, s96, s95
    s_add_u32 s95, s95, 5242880
    s_lshr_b32 s80, s68, 3
    s_lshl_b32 s80, s80, 11
    s_add_u32 s80, s80, s72
    s_xor_b32 s81, s77, 1
    s_lshl_b32 s81, s81, 10
    s_add_u32 s80, s80, s81
    s_add_u32 s94, s80, 1024
    s_waitcnt lgkmcnt(0)
    s_add_u32 s70, s70, 2654435769
    s_add_u32 s71, s71, 2654435769
    s_waitcnt vmcnt(8)
    s_barrier
    s_add_u32 m0, s75, 24576
    s_nop 0
    buffer_load_dwordx4 v12, s[32:35], s84 offen lds
    buffer_load_dwordx4 v13, s[32:35], s84 offen offset:1024 lds
    s_add_u32 m0, s75, 26624
    s_nop 0
    buffer_load_dwordx4 v12, s[36:39], s84 offen lds
    buffer_load_dwordx4 v13, s[36:39], s84 offen offset:1024 lds
    s_add_u32 m0, s75, 28672
    s_nop 0
    s_mov_b32 exec_lo, 0
    buffer_load_dwordx4 v24, s[32:35], 0 offen lds
    s_mov_b32 exec_lo, -1
    s_waitcnt vmcnt(5)
    s_barrier
    s_add_u32 m0, s75, 16384
    s_add_u32 s85, s85, 128
    buffer_load_dwordx4 v12, s[28:31], s85 offen lds
    buffer_load_dwordx4 v13, s[28:31], s85 offen offset:1024 lds
    buffer_load_dwordx4 v14, s[28:31], s85 offen offset:2048 lds
    buffer_load_dwordx4 v15, s[28:31], s85 offen offset:3072 lds
    s_add_u32 m0, s75, 20480
    s_add_u32 s86, s86, 229376
    buffer_load_dwordx4 v20, s[44:47], s86 offen lds
    buffer_load_dwordx4 v21, s[44:47], s86 offen offset:1024 lds
    buffer_load_dwordx4 v22, s[44:47], s86 offen offset:2048 lds
    buffer_load_dwordx4 v23, s[44:47], s86 offen offset:3072 lds
    s_waitcnt vmcnt(8)
    s_barrier
    s_add_u32 m0, s75, 0
    s_add_u32 s85, s85, 128
    buffer_load_dwordx4 v12, s[28:31], s85 offen lds
    buffer_load_dwordx4 v13, s[28:31], s85 offen offset:1024 lds
    buffer_load_dwordx4 v14, s[28:31], s85 offen offset:2048 lds
    buffer_load_dwordx4 v15, s[28:31], s85 offen offset:3072 lds
    s_add_u32 m0, s75, 4096
    s_add_u32 s86, s86, 229376
    buffer_load_dwordx4 v20, s[44:47], s86 offen lds
    buffer_load_dwordx4 v21, s[44:47], s86 offen offset:1024 lds
    buffer_load_dwordx4 v22, s[44:47], s86 offen offset:2048 lds
    buffer_load_dwordx4 v23, s[44:47], s86 offen offset:3072 lds
    s_waitcnt vmcnt(8)
    s_barrier
    s_add_u32 m0, s75, 8192
    s_add_u32 s85, s85, 128
    buffer_load_dwordx4 v12, s[28:31], s85 offen lds
    buffer_load_dwordx4 v13, s[28:31], s85 offen offset:1024 lds
    buffer_load_dwordx4 v14, s[28:31], s85 offen offset:2048 lds
    buffer_load_dwordx4 v15, s[28:31], s85 offen offset:3072 lds
    s_add_u32 m0, s75, 12288
    s_add_u32 s86, s86, 229376
    buffer_load_dwordx4 v20, s[44:47], s86 offen lds
    buffer_load_dwordx4 v21, s[44:47], s86 offen offset:1024 lds
    buffer_load_dwordx4 v22, s[44:47], s86 offen offset:2048 lds
    buffer_load_dwordx4 v23, s[44:47], s86 offen offset:3072 lds
    s_waitcnt vmcnt(8)
    s_barrier
    s_add_u32 m0, s75, 16384
    s_add_u32 s85, s85, 128
    buffer_load_dwordx4 v12, s[28:31], s85 offen lds
    buffer_load_dwordx4 v13, s[28:31], s85 offen offset:1024 lds
    buffer_load_dwordx4 v14, s[28:31], s85 offen offset:2048 lds
    buffer_load_dwordx4 v15, s[28:31], s85 offen offset:3072 lds
    s_add_u32 m0, s75, 20480
    s_add_u32 s86, s86, 229376
    buffer_load_dwordx4 v20, s[44:47], s86 offen lds
    buffer_load_dwordx4 v21, s[44:47], s86 offen offset:1024 lds
    buffer_load_dwordx4 v22, s[44:47], s86 offen offset:2048 lds
    buffer_load_dwordx4 v23, s[44:47], s86 offen offset:3072 lds
    s_waitcnt vmcnt(8)
    s_barrier
    s_add_u32 m0, s75, 0
    s_add_u32 s85, s85, 128
    buffer_load_dwordx4 v12, s[28:31], s85 offen lds
    buffer_load_dwordx4 v13, s[28:31], s85 offen offset:1024 lds
    buffer_load_dwordx4 v14, s[28:31], s85 offen offset:2048 lds
    buffer_load_dwordx4 v15, s[28:31], s85 offen offset:3072 lds
    s_add_u32 m0, s75, 4096
    s_add_u32 s86, s86, 229376
    buffer_load_dwordx4 v20, s[44:47], s86 offen lds
    buffer_load_dwordx4 v21, s[44:47], s86 offen offset:1024 lds
    buffer_load_dwordx4 v22, s[44:47], s86 offen offset:2048 lds
    buffer_load_dwordx4 v23, s[44:47], s86 offen offset:3072 lds
    s_waitcnt vmcnt(8)
    s_barrier
    s_bfm_b64 exec, 16, 0
    buffer_load_dword v16, v26, s[56:59], s94 offen sc1
    s_mov_b64 exec, -1
    s_lshl1_add_u32 s80, s76, s77
    s_lshl_b32 s80, s80, 11
    s_mul_i32 s81, s78, 12928
    s_lshl_b32 s82, s77, 11
    s_add_u32 s81, s81, s82
    s_add_u32 m0, s81, 131136
    s_nop 0
    buffer_load_dwordx4 v1, s[40:43], s80 offen lds
    buffer_load_dwordx4 v1, s[40:43], s80 offen offset:1024 lds
    s_lshl1_add_u32 s80, s76, s77
    s_lshl_b32 s80, s80, 11
    s_add_u32 s80, s80, 2
    s_mul_i32 s81, s78, 12928
    s_lshl_b32 s82, s77, 11
    s_add_u32 s81, s81, s82
    s_add_u32 m0, s81, 135296
    s_nop 0
    buffer_load_dwordx4 v1, s[40:43], s80 offen lds
    buffer_load_dwordx4 v1, s[40:43], s80 offen offset:1024 lds
    s_waitcnt vmcnt(5)
    s_barrier
    s_waitcnt vmcnt(4)
    s_bfm_b64 exec, 16, 0
    v_cmp_ne_u32 vcc, s70, v16
    s_mov_b64 exec, -1
    s_cbranch_vccz KVN_2
    s_bfm_b64 exec, 16, 0
    s_mov_b32 s83, 0
POLL_3:
    buffer_load_dword v16, v26, s[56:59], s94 offen sc1
    s_waitcnt vmcnt(0)
    v_cmp_ne_u32 vcc, s70, v16
    s_add_u32 s83, s83, 1
    s_cmp_gt_u32 s83, 100000
    s_cbranch_scc1 POLLX_4
    s_cbranch_vccz POLLX_4
    s_branch POLL_3
POLLX_4:
    s_mov_b64 exec, -1
KVN_2:
    s_lshr_b32 s80, s76, 1
    s_lshl1_add_u32 s80, s80, s77
    s_lshl_b32 s80, s80, 12
    s_lshl4_add_u32 s80, s78, s80
    s_add_u32 s80, s80, 1048576
    s_mul_i32 s81, s78, 12928
    s_lshl_b32 s82, s77, 11
    s_add_u32 s81, s81, s82
    s_add_u32 m0, s81, 139392
    v_lshlrev_b32 v17, 1, v1
    s_add_u32 s82, s80, 1024
    buffer_load_dwordx4 v17, s[56:59], s80 offen sc1 lds
    buffer_load_dwordx4 v17, s[56:59], s82 offen offset:1024 sc1 lds
    s_mul_i32 s87, s91, 7
    s_add_u32 m0, s75, 28672
    s_add_u32 s87, s87, s92
    buffer_load_dwordx4 v4, s[48:51], s87 offen lds
    buffer_load_dwordx4 v5, s[48:51], s87 offen offset:1024 lds
    buffer_load_dwordx4 v6, s[48:51], s87 offen offset:2048 lds
    buffer_load_dwordx4 v7, s[48:51], s87 offen offset:3072 lds
    s_mul_i32 s87, s4, 7
    s_add_u32 m0, s75, 24576
    s_add_u32 s87, s87, s92
    buffer_load_dwordx4 v4, s[48:51], s87 offen lds
    buffer_load_dwordx4 v5, s[48:51], s87 offen offset:1024 lds
    buffer_load_dwordx4 v6, s[48:51], s87 offen offset:2048 lds
    buffer_load_dwordx4 v7, s[48:51], s87 offen offset:3072 lds
    s_waitcnt vmcnt(8) lgkmcnt(0)
    s_barrier
    s_mul_i32 s87, s5, 7
    s_add_u32 m0, s75, 8192
    s_add_u32 s87, s87, s92
    buffer_load_dwordx4 v4, s[48:51], s87 offen lds
    buffer_load_dwordx4 v5, s[48:51], s87 offen offset:1024 lds
    buffer_load_dwordx4 v6, s[48:51], s87 offen offset:2048 lds
    buffer_load_dwordx4 v7, s[48:51], s87 offen offset:3072 lds
    v_lshrrev_b32 v2, 8, v1
    v_lshlrev_b32 v2, 6, v2
    v_xor_b32 v2, v2, v1
    v_add_u32 v2, s75, v2
    s_lshl2_add_u32 s80, s60, 158752
    v_mov_b32 v3, s80
    s_waitcnt vmcnt(8)
    ds_read_b64_tr_b16 v[144:145], v8 offset:28672
    ds_read_b64_tr_b16 v[146:147], v8 offset:30720
    ds_read_b64_tr_b16 v[148:149], v9 offset:28672
    ds_read_b64_tr_b16 v[150:151], v9 offset:30720
    ds_read_b64_tr_b16 v[152:153], v10 offset:28672
    ds_read_b64_tr_b16 v[154:155], v10 offset:30720
    ds_read_b64_tr_b16 v[156:157], v11 offset:28672
    ds_read_b64_tr_b16 v[158:159], v11 offset:30720
    s_waitcnt vmcnt(4)
    ds_read_b64_tr_b16 v[160:161], v8 offset:24576
    ds_read_b64_tr_b16 v[162:163], v8 offset:26624
    ds_read_b64_tr_b16 v[164:165], v9 offset:24576
    ds_read_b64_tr_b16 v[166:167], v9 offset:26624
    ds_read_b64_tr_b16 v[168:169], v10 offset:24576
    ds_read_b64_tr_b16 v[170:171], v10 offset:26624
    ds_read_b64_tr_b16 v[172:173], v11 offset:24576
    ds_read_b64_tr_b16 v[174:175], v11 offset:26624
    s_waitcnt vmcnt(0)
    ds_read_b64_tr_b16 v[176:177], v8 offset:8192
    ds_read_b64_tr_b16 v[178:179], v8 offset:10240
    ds_read_b64_tr_b16 v[180:181], v9 offset:8192
    ds_read_b64_tr_b16 v[182:183], v9 offset:10240
    ds_read_b64_tr_b16 v[184:185], v10 offset:8192
    ds_read_b64_tr_b16 v[186:187], v10 offset:10240
    ds_read_b64_tr_b16 v[188:189], v11 offset:8192
    ds_read_b64_tr_b16 v[190:191], v11 offset:10240
    v_and_b32 v17, 0x30, v1
    v_lshrrev_b32 v17, 2, v17
    v_add_u32 v17, 158784, v17
    v_add_u32 v19, s75, v1
    s_mov_b32 s83, 0
BS_5:
    ds_read_b32 v18, v17
    s_add_u32 s83, s83, 1
    s_waitcnt lgkmcnt(0)
    v_cmp_eq_u32 vcc, 0, v18
    s_cmp_gt_u32 s83, 800000
    s_cbranch_scc1 BSX_6
    s_cbranch_vccz BSX_6
    s_sleep 1
    s_branch BS_5
BSX_6:
    ds_read_b128 v[80:83], v19 offset:16384
    ds_read_b128 v[84:87], v19 offset:17408
    ds_read_b128 v[88:91], v19 offset:18432
    ds_read_b128 v[92:95], v19 offset:19456
    ds_read_b128 v[96:99], v19 offset:20480
    ds_read_b128 v[100:103], v19 offset:21504
    ds_read_b128 v[104:107], v19 offset:22528
    ds_read_b128 v[108:111], v19 offset:23552
    ds_write_b32 v3, v3 offset:48
    s_mul_i32 s87, s6, 7
    s_add_u32 m0, s75, 12288
    s_add_u32 s87, s87, s92
    buffer_load_dwordx4 v4, s[48:51], s87 offen lds
    buffer_load_dwordx4 v5, s[48:51], s87 offen offset:1024 lds
    buffer_load_dwordx4 v6, s[48:51], s87 offen offset:2048 lds
    buffer_load_dwordx4 v7, s[48:51], s87 offen offset:3072 lds
    s_mul_i32 s87, s7, 7
    s_add_u32 m0, s75, 0
    s_add_u32 s87, s87, s92
    buffer_load_dwordx4 v4, s[48:51], s87 offen lds
    buffer_load_dwordx4 v5, s[48:51], s87 offen offset:1024 lds
    buffer_load_dwordx4 v6, s[48:51], s87 offen offset:2048 lds
    buffer_load_dwordx4 v7, s[48:51], s87 offen offset:3072 lds
    s_mov_b32 s83, 0
LW_7:
    ds_read_b32 v18, v3 offset:64
    s_add_u32 s83, s83, 1
    s_waitcnt lgkmcnt(0)
    v_readfirstlane_b32 s82, v18
    s_cmp_gt_u32 s83, 800000
    s_cbranch_scc1 LWX_8
    s_cmp_ge_u32 s82, 1
    s_cbranch_scc1 LWX_8
    s_sleep 1
    s_branch LW_7
LWX_8:
    s_mul_i32 s87, s8, 7
    s_add_u32 m0, s75, 4096
    s_add_u32 s87, s87, s92
    buffer_load_dwordx4 v4, s[48:51], s87 offen lds
    buffer_load_dwordx4 v5, s[48:51], s87 offen offset:1024 lds
    buffer_load_dwordx4 v6, s[48:51], s87 offen offset:2048 lds
    buffer_load_dwordx4 v7, s[48:51], s87 offen offset:3072 lds
    s_mul_i32 s87, s9, 7
    s_add_u32 m0, s75, 28672
    s_add_u32 s87, s87, s92
    buffer_load_dwordx4 v4, s[48:51], s87 offen lds
    buffer_load_dwordx4 v5, s[48:51], s87 offen offset:1024 lds
    buffer_load_dwordx4 v6, s[48:51], s87 offen offset:2048 lds
    buffer_load_dwordx4 v7, s[48:51], s87 offen offset:3072 lds
    s_waitcnt vmcnt(12)
    ds_read_b64_tr_b16 v[192:193], v8 offset:12288
    ds_read_b64_tr_b16 v[194:195], v8 offset:14336
    ds_read_b64_tr_b16 v[196:197], v9 offset:12288
    ds_read_b64_tr_b16 v[198:199], v9 offset:14336
    ds_read_b64_tr_b16 v[200:201], v10 offset:12288
    ds_read_b64_tr_b16 v[202:203], v10 offset:14336
    ds_read_b64_tr_b16 v[204:205], v11 offset:12288
    ds_read_b64_tr_b16 v[206:207], v11 offset:14336
    s_waitcnt vmcnt(8)
    ds_read_b64_tr_b16 v[208:209], v8 offset:0
    ds_read_b64_tr_b16 v[210:211], v8 offset:2048
    ds_read_b64_tr_b16 v[212:213], v9 offset:0
    ds_read_b64_tr_b16 v[214:215], v9 offset:2048
    ds_read_b64_tr_b16 v[216:217], v10 offset:0
    ds_read_b64_tr_b16 v[218:219], v10 offset:2048
    ds_read_b64_tr_b16 v[220:221], v11 offset:0
    ds_read_b64_tr_b16 v[222:223], v11 offset:2048
    s_waitcnt vmcnt(4)
    ds_read_b64_tr_b16 v[224:225], v8 offset:4096
    ds_read_b64_tr_b16 v[226:227], v8 offset:6144
    ds_read_b64_tr_b16 v[228:229], v9 offset:4096
    ds_read_b64_tr_b16 v[230:231], v9 offset:6144
    ds_read_b64_tr_b16 v[232:233], v10 offset:4096
    ds_read_b64_tr_b16 v[234:235], v10 offset:6144
    ds_read_b64_tr_b16 v[236:237], v11 offset:4096
    ds_read_b64_tr_b16 v[238:239], v11 offset:6144
    s_bfm_b64 exec, 10, 0
    buffer_load_dword v16, v26, s[56:59], s90 offen sc1
    s_mov_b64 exec, -1
    s_waitcnt vmcnt(1)
    ds_read_b64_tr_b16 v[240:241], v8 offset:28672
    ds_read_b64_tr_b16 v[242:243], v8 offset:30720
    ds_read_b64_tr_b16 v[244:245], v9 offset:28672
    ds_read_b64_tr_b16 v[246:247], v9 offset:30720
    ds_read_b64_tr_b16 v[248:249], v10 offset:28672
    ds_read_b64_tr_b16 v[250:251], v10 offset:30720
    ds_read_b64_tr_b16 v[252:253], v11 offset:28672
    ds_read_b64_tr_b16 v[254:255], v11 offset:30720
    v_add_u32 v1, s95, v1
    s_waitcnt vmcnt(0)
    s_bfm_b64 exec, 10, 0
    v_cmp_ne_u32 vcc, s71, v16
    s_mov_b64 exec, -1
    s_cbranch_vccz HN_9
    s_bfm_b64 exec, 10, 0
    s_mov_b32 s83, 0
POLL_10:
    buffer_load_dword v16, v26, s[56:59], s90 offen sc1
    s_waitcnt vmcnt(0)
    v_cmp_ne_u32 vcc, s71, v16
    s_add_u32 s83, s83, 1
    s_cmp_gt_u32 s83, 100000
    s_cbranch_scc1 POLLX_11
    s_cbranch_vccz POLLX_11
    s_branch POLL_10
POLLX_11:
    s_mov_b64 exec, -1
HN_9:
    buffer_load_dwordx4 v[12:15], v1, s[56:59], s4 offen sc1
    buffer_load_dwordx4 v[16:19], v1, s[56:59], s5 offen sc1
    buffer_load_dwordx4 v[20:23], v1, s[56:59], s6 offen sc1
    buffer_load_dwordx4 v[24:27], v1, s[56:59], s7 offen sc1
    buffer_load_dwordx4 v[28:31], v1, s[56:59], s8 offen sc1
    buffer_load_dwordx4 v[32:35], v1, s[56:59], s9 offen sc1
    buffer_load_dwordx4 v[36:39], v1, s[56:59], s4 offen offset:1024 sc1
    buffer_load_dwordx4 v[40:43], v1, s[56:59], s5 offen offset:1024 sc1
    buffer_load_dwordx4 v[44:47], v1, s[56:59], s6 offen offset:1024 sc1
    buffer_load_dwordx4 v[48:51], v1, s[56:59], s7 offen offset:1024 sc1
    buffer_load_dwordx4 v[52:55], v1, s[56:59], s8 offen offset:1024 sc1
    buffer_load_dwordx4 v[56:59], v1, s[56:59], s9 offen offset:1024 sc1
    buffer_load_dwordx4 v[60:63], v1, s[56:59], s4 offen offset:2048 sc1
    buffer_load_dwordx4 v[64:67], v1, s[56:59], s5 offen offset:2048 sc1
    buffer_load_dwordx4 v[68:71], v1, s[56:59], s6 offen offset:2048 sc1
    buffer_load_dwordx4 v[72:75], v1, s[56:59], s7 offen offset:2048 sc1
    s_waitcnt lgkmcnt(0)
    v_mfma_f32_16x16x32_bf16 v[112:115], v[144:147], v[80:83], 0
    v_mfma_f32_16x16x32_bf16 v[116:119], v[148:151], v[80:83], 0
    v_mfma_f32_16x16x32_bf16 v[120:123], v[152:155], v[80:83], 0
    v_mfma_f32_16x16x32_bf16 v[124:127], v[156:159], v[80:83], 0
    s_waitcnt vmcnt(15)
    v_mfma_f32_16x16x32_bf16 v[112:115], v[160:163], v[12:15], v[112:115]
    v_mfma_f32_16x16x32_bf16 v[116:119], v[164:167], v[12:15], v[116:119]
    v_mfma_f32_16x16x32_bf16 v[120:123], v[168:171], v[12:15], v[120:123]
    v_mfma_f32_16x16x32_bf16 v[124:127], v[172:175], v[12:15], v[124:127]
    s_waitcnt vmcnt(14)
    v_mfma_f32_16x16x32_bf16 v[112:115], v[176:179], v[16:19], v[112:115]
    v_mfma_f32_16x16x32_bf16 v[116:119], v[180:183], v[16:19], v[116:119]
    buffer_load_dwordx4 v[12:15], v1, s[56:59], s8 offen offset:2048 sc1
    v_mfma_f32_16x16x32_bf16 v[120:123], v[184:187], v[16:19], v[120:123]
    v_mfma_f32_16x16x32_bf16 v[124:127], v[188:191], v[16:19], v[124:127]
    s_waitcnt vmcnt(14)
    v_mfma_f32_16x16x32_bf16 v[112:115], v[192:195], v[20:23], v[112:115]
    v_mfma_f32_16x16x32_bf16 v[116:119], v[196:199], v[20:23], v[116:119]
    buffer_load_dwordx4 v[16:19], v1, s[56:59], s9 offen offset:2048 sc1
    v_mfma_f32_16x16x32_bf16 v[120:123], v[200:203], v[20:23], v[120:123]
    v_mfma_f32_16x16x32_bf16 v[124:127], v[204:207], v[20:23], v[124:127]
    s_waitcnt vmcnt(14)
    v_mfma_f32_16x16x32_bf16 v[112:115], v[208:211], v[24:27], v[112:115]
    v_mfma_f32_16x16x32_bf16 v[116:119], v[212:215], v[24:27], v[116:119]
    buffer_load_dwordx4 v[20:23], v1, s[56:59], s4 offen offset:3072 sc1
    v_mfma_f32_16x16x32_bf16 v[120:123], v[216:219], v[24:27], v[120:123]
    v_mfma_f32_16x16x32_bf16 v[124:127], v[220:223], v[24:27], v[124:127]
    s_waitcnt vmcnt(14)
    v_mfma_f32_16x16x32_bf16 v[112:115], v[224:227], v[28:31], v[112:115]
    v_mfma_f32_16x16x32_bf16 v[116:119], v[228:231], v[28:31], v[116:119]
    buffer_load_dwordx4 v[24:27], v1, s[56:59], s5 offen offset:3072 sc1
    v_mfma_f32_16x16x32_bf16 v[120:123], v[232:235], v[28:31], v[120:123]
    v_mfma_f32_16x16x32_bf16 v[124:127], v[236:239], v[28:31], v[124:127]
    s_waitcnt vmcnt(14)
    v_mfma_f32_16x16x32_bf16 v[112:115], v[240:243], v[32:35], v[112:115]
    v_mfma_f32_16x16x32_bf16 v[116:119], v[244:247], v[32:35], v[116:119]
    buffer_load_dwordx4 v[28:31], v1, s[56:59], s6 offen offset:3072 sc1
    v_mfma_f32_16x16x32_bf16 v[120:123], v[248:251], v[32:35], v[120:123]
    v_mfma_f32_16x16x32_bf16 v[124:127], v[252:255], v[32:35], v[124:127]
    v_mfma_f32_16x16x32_bf16 v[128:131], v[144:147], v[84:87], 0
    v_mfma_f32_16x16x32_bf16 v[132:135], v[148:151], v[84:87], 0
    buffer_load_dwordx4 v[32:35], v1, s[56:59], s7 offen offset:3072 sc1
    v_mfma_f32_16x16x32_bf16 v[136:139], v[152:155], v[84:87], 0
    v_mfma_f32_16x16x32_bf16 v[140:143], v[156:159], v[84:87], 0
    s_nop 0
    ds_write_b128 v2, v[112:115] offset:0
    s_waitcnt vmcnt(15)
    v_mfma_f32_16x16x32_bf16 v[128:131], v[160:163], v[36:39], v[128:131]
    ds_write_b128 v2, v[116:119] offset:1024
    v_mfma_f32_16x16x32_bf16 v[132:135], v[164:167], v[36:39], v[132:135]
    ds_write_b128 v2, v[120:123] offset:2048
    v_mfma_f32_16x16x32_bf16 v[136:139], v[168:171], v[36:39], v[136:139]
    ds_write_b128 v2, v[124:127] offset:3072
    v_mfma_f32_16x16x32_bf16 v[140:143], v[172:175], v[36:39], v[140:143]
    ds_write_b32 v3, v3 offset:96
    s_waitcnt vmcnt(14)
    v_mfma_f32_16x16x32_bf16 v[128:131], v[176:179], v[40:43], v[128:131]
    v_mfma_f32_16x16x32_bf16 v[132:135], v[180:183], v[40:43], v[132:135]
    buffer_load_dwordx4 v[36:39], v1, s[56:59], s8 offen offset:3072 sc1
    v_mfma_f32_16x16x32_bf16 v[136:139], v[184:187], v[40:43], v[136:139]
    v_mfma_f32_16x16x32_bf16 v[140:143], v[188:191], v[40:43], v[140:143]
    s_waitcnt vmcnt(14)
    v_mfma_f32_16x16x32_bf16 v[128:131], v[192:195], v[44:47], v[128:131]
    v_mfma_f32_16x16x32_bf16 v[132:135], v[196:199], v[44:47], v[132:135]
    buffer_load_dwordx4 v[40:43], v1, s[56:59], s9 offen offset:3072 sc1
    v_mfma_f32_16x16x32_bf16 v[136:139], v[200:203], v[44:47], v[136:139]
    v_mfma_f32_16x16x32_bf16 v[140:143], v[204:207], v[44:47], v[140:143]
    s_waitcnt vmcnt(14)
    v_mfma_f32_16x16x32_bf16 v[128:131], v[208:211], v[48:51], v[128:131]
    v_mfma_f32_16x16x32_bf16 v[132:135], v[212:215], v[48:51], v[132:135]
    v_add_u32 v1, s96, v1
    buffer_load_dwordx4 v[44:47], v1, s[56:59], s4 offen sc1
    v_mfma_f32_16x16x32_bf16 v[136:139], v[216:219], v[48:51], v[136:139]
    v_mfma_f32_16x16x32_bf16 v[140:143], v[220:223], v[48:51], v[140:143]
    s_waitcnt vmcnt(14)
    v_mfma_f32_16x16x32_bf16 v[128:131], v[224:227], v[52:55], v[128:131]
    v_mfma_f32_16x16x32_bf16 v[132:135], v[228:231], v[52:55], v[132:135]
    buffer_load_dwordx4 v[48:51], v1, s[56:59], s5 offen sc1
    v_mfma_f32_16x16x32_bf16 v[136:139], v[232:235], v[52:55], v[136:139]
    v_mfma_f32_16x16x32_bf16 v[140:143], v[236:239], v[52:55], v[140:143]
    s_waitcnt vmcnt(14)
    v_mfma_f32_16x16x32_bf16 v[128:131], v[240:243], v[56:59], v[128:131]
    v_mfma_f32_16x16x32_bf16 v[132:135], v[244:247], v[56:59], v[132:135]
    buffer_load_dwordx4 v[52:55], v1, s[56:59], s6 offen sc1
    v_mfma_f32_16x16x32_bf16 v[136:139], v[248:251], v[56:59], v[136:139]
    v_mfma_f32_16x16x32_bf16 v[140:143], v[252:255], v[56:59], v[140:143]
    v_mfma_f32_16x16x32_bf16 v[112:115], v[144:147], v[88:91], 0
    v_mfma_f32_16x16x32_bf16 v[116:119], v[148:151], v[88:91], 0
    buffer_load_dwordx4 v[56:59], v1, s[56:59], s7 offen sc1
    v_mfma_f32_16x16x32_bf16 v[120:123], v[152:155], v[88:91], 0
    v_mfma_f32_16x16x32_bf16 v[124:127], v[156:159], v[88:91], 0
    s_nop 0
    ds_write_b128 v2, v[128:131] offset:4096
    s_waitcnt vmcnt(15)
    v_mfma_f32_16x16x32_bf16 v[112:115], v[160:163], v[60:63], v[112:115]
    ds_write_b128 v2, v[132:135] offset:5120
    v_mfma_f32_16x16x32_bf16 v[116:119], v[164:167], v[60:63], v[116:119]
    ds_write_b128 v2, v[136:139] offset:6144
    v_mfma_f32_16x16x32_bf16 v[120:123], v[168:171], v[60:63], v[120:123]
    ds_write_b128 v2, v[140:143] offset:7168
    v_mfma_f32_16x16x32_bf16 v[124:127], v[172:175], v[60:63], v[124:127]
    ds_write_b32 v3, v3 offset:112
    s_waitcnt vmcnt(14)
    v_mfma_f32_16x16x32_bf16 v[112:115], v[176:179], v[64:67], v[112:115]
    v_mfma_f32_16x16x32_bf16 v[116:119], v[180:183], v[64:67], v[116:119]
    buffer_load_dwordx4 v[60:63], v1, s[56:59], s8 offen sc1
    v_mfma_f32_16x16x32_bf16 v[120:123], v[184:187], v[64:67], v[120:123]
    v_mfma_f32_16x16x32_bf16 v[124:127], v[188:191], v[64:67], v[124:127]
    s_waitcnt vmcnt(14)
    v_mfma_f32_16x16x32_bf16 v[112:115], v[192:195], v[68:71], v[112:115]
    v_mfma_f32_16x16x32_bf16 v[116:119], v[196:199], v[68:71], v[116:119]
    buffer_load_dwordx4 v[64:67], v1, s[56:59], s9 offen sc1
    v_mfma_f32_16x16x32_bf16 v[120:123], v[200:203], v[68:71], v[120:123]
    v_mfma_f32_16x16x32_bf16 v[124:127], v[204:207], v[68:71], v[124:127]
    s_waitcnt vmcnt(14)
    v_mfma_f32_16x16x32_bf16 v[112:115], v[208:211], v[72:75], v[112:115]
    v_mfma_f32_16x16x32_bf16 v[116:119], v[212:215], v[72:75], v[116:119]
    buffer_load_dwordx4 v[68:71], v1, s[56:59], s4 offen offset:1024 sc1
    v_mfma_f32_16x16x32_bf16 v[120:123], v[216:219], v[72:75], v[120:123]
    v_mfma_f32_16x16x32_bf16 v[124:127], v[220:223], v[72:75], v[124:127]
    s_waitcnt vmcnt(14)
    v_mfma_f32_16x16x32_bf16 v[112:115], v[224:227], v[12:15], v[112:115]
    v_mfma_f32_16x16x32_bf16 v[116:119], v[228:231], v[12:15], v[116:119]
    buffer_load_dwordx4 v[72:75], v1, s[56:59], s5 offen offset:1024 sc1
    v_mfma_f32_16x16x32_bf16 v[120:123], v[232:235], v[12:15], v[120:123]
    v_mfma_f32_16x16x32_bf16 v[124:127], v[236:239], v[12:15], v[124:127]
    s_waitcnt vmcnt(14)
    v_mfma_f32_16x16x32_bf16 v[112:115], v[240:243], v[16:19], v[112:115]
    v_mfma_f32_16x16x32_bf16 v[116:119], v[244:247], v[16:19], v[116:119]
    buffer_load_dwordx4 v[12:15], v1, s[56:59], s6 offen offset:1024 sc1
    v_mfma_f32_16x16x32_bf16 v[120:123], v[248:251], v[16:19], v[120:123]
    v_mfma_f32_16x16x32_bf16 v[124:127], v[252:255], v[16:19], v[124:127]
    v_mfma_f32_16x16x32_bf16 v[128:131], v[144:147], v[92:95], 0
    v_mfma_f32_16x16x32_bf16 v[132:135], v[148:151], v[92:95], 0
    buffer_load_dwordx4 v[16:19], v1, s[56:59], s7 offen offset:1024 sc1
    v_mfma_f32_16x16x32_bf16 v[136:139], v[152:155], v[92:95], 0
    v_mfma_f32_16x16x32_bf16 v[140:143], v[156:159], v[92:95], 0
    s_nop 0
    ds_write_b128 v2, v[112:115] offset:8192
    s_waitcnt vmcnt(15)
    v_mfma_f32_16x16x32_bf16 v[128:131], v[160:163], v[20:23], v[128:131]
    ds_write_b128 v2, v[116:119] offset:9216
    v_mfma_f32_16x16x32_bf16 v[132:135], v[164:167], v[20:23], v[132:135]
    ds_write_b128 v2, v[120:123] offset:10240
    v_mfma_f32_16x16x32_bf16 v[136:139], v[168:171], v[20:23], v[136:139]
    ds_write_b128 v2, v[124:127] offset:11264
    v_mfma_f32_16x16x32_bf16 v[140:143], v[172:175], v[20:23], v[140:143]
    ds_write_b32 v3, v3 offset:128
    s_waitcnt vmcnt(14)
    v_mfma_f32_16x16x32_bf16 v[128:131], v[176:179], v[24:27], v[128:131]
    v_mfma_f32_16x16x32_bf16 v[132:135], v[180:183], v[24:27], v[132:135]
    buffer_load_dwordx4 v[20:23], v1, s[56:59], s8 offen offset:1024 sc1
    v_mfma_f32_16x16x32_bf16 v[136:139], v[184:187], v[24:27], v[136:139]
    v_mfma_f32_16x16x32_bf16 v[140:143], v[188:191], v[24:27], v[140:143]
    s_waitcnt vmcnt(14)
    v_mfma_f32_16x16x32_bf16 v[128:131], v[192:195], v[28:31], v[128:131]
    v_mfma_f32_16x16x32_bf16 v[132:135], v[196:199], v[28:31], v[132:135]
    buffer_load_dwordx4 v[24:27], v1, s[56:59], s9 offen offset:1024 sc1
    v_mfma_f32_16x16x32_bf16 v[136:139], v[200:203], v[28:31], v[136:139]
    v_mfma_f32_16x16x32_bf16 v[140:143], v[204:207], v[28:31], v[140:143]
    s_waitcnt vmcnt(14)
    v_mfma_f32_16x16x32_bf16 v[128:131], v[208:211], v[32:35], v[128:131]
    v_mfma_f32_16x16x32_bf16 v[132:135], v[212:215], v[32:35], v[132:135]
    buffer_load_dwordx4 v[28:31], v1, s[56:59], s4 offen offset:2048 sc1
    v_mfma_f32_16x16x32_bf16 v[136:139], v[216:219], v[32:35], v[136:139]
    v_mfma_f32_16x16x32_bf16 v[140:143], v[220:223], v[32:35], v[140:143]
    s_waitcnt vmcnt(14)
    v_mfma_f32_16x16x32_bf16 v[128:131], v[224:227], v[36:39], v[128:131]
    v_mfma_f32_16x16x32_bf16 v[132:135], v[228:231], v[36:39], v[132:135]
    buffer_load_dwordx4 v[32:35], v1, s[56:59], s5 offen offset:2048 sc1
    v_mfma_f32_16x16x32_bf16 v[136:139], v[232:235], v[36:39], v[136:139]
    v_mfma_f32_16x16x32_bf16 v[140:143], v[236:239], v[36:39], v[140:143]
    s_waitcnt vmcnt(14)
    v_mfma_f32_16x16x32_bf16 v[128:131], v[240:243], v[40:43], v[128:131]
    v_mfma_f32_16x16x32_bf16 v[132:135], v[244:247], v[40:43], v[132:135]
    buffer_load_dwordx4 v[36:39], v1, s[56:59], s6 offen offset:2048 sc1
    v_mfma_f32_16x16x32_bf16 v[136:139], v[248:251], v[40:43], v[136:139]
    v_mfma_f32_16x16x32_bf16 v[140:143], v[252:255], v[40:43], v[140:143]
    v_mfma_f32_16x16x32_bf16 v[112:115], v[144:147], v[96:99], 0
    v_mfma_f32_16x16x32_bf16 v[116:119], v[148:151], v[96:99], 0
    buffer_load_dwordx4 v[40:43], v1, s[56:59], s7 offen offset:2048 sc1
    v_mfma_f32_16x16x32_bf16 v[120:123], v[152:155], v[96:99], 0
    v_mfma_f32_16x16x32_bf16 v[124:127], v[156:159], v[96:99], 0
    s_nop 0
    ds_write_b128 v2, v[128:131] offset:12288
    s_waitcnt vmcnt(15)
    v_mfma_f32_16x16x32_bf16 v[112:115], v[160:163], v[44:47], v[112:115]
    ds_write_b128 v2, v[132:135] offset:13312
    v_mfma_f32_16x16x32_bf16 v[116:119], v[164:167], v[44:47], v[116:119]
    ds_write_b128 v2, v[136:139] offset:14336
    v_mfma_f32_16x16x32_bf16 v[120:123], v[168:171], v[44:47], v[120:123]
    ds_write_b128 v2, v[140:143] offset:15360
    v_mfma_f32_16x16x32_bf16 v[124:127], v[172:175], v[44:47], v[124:127]
    ds_write_b32 v3, v3 offset:144
    s_waitcnt vmcnt(14)
    v_mfma_f32_16x16x32_bf16 v[112:115], v[176:179], v[48:51], v[112:115]
    v_mfma_f32_16x16x32_bf16 v[116:119], v[180:183], v[48:51], v[116:119]
    buffer_load_dwordx4 v[44:47], v1, s[56:59], s8 offen offset:2048 sc1
    v_mfma_f32_16x16x32_bf16 v[120:123], v[184:187], v[48:51], v[120:123]
    v_mfma_f32_16x16x32_bf16 v[124:127], v[188:191], v[48:51], v[124:127]
    s_waitcnt vmcnt(14)
    v_mfma_f32_16x16x32_bf16 v[112:115], v[192:195], v[52:55], v[112:115]
    v_mfma_f32_16x16x32_bf16 v[116:119], v[196:199], v[52:55], v[116:119]
    buffer_load_dwordx4 v[48:51], v1, s[56:59], s9 offen offset:2048 sc1
    v_mfma_f32_16x16x32_bf16 v[120:123], v[200:203], v[52:55], v[120:123]
    v_mfma_f32_16x16x32_bf16 v[124:127], v[204:207], v[52:55], v[124:127]
    s_waitcnt vmcnt(14)
    v_mfma_f32_16x16x32_bf16 v[112:115], v[208:211], v[56:59], v[112:115]
    v_mfma_f32_16x16x32_bf16 v[116:119], v[212:215], v[56:59], v[116:119]
    buffer_load_dwordx4 v[52:55], v1, s[56:59], s4 offen offset:3072 sc1
    v_mfma_f32_16x16x32_bf16 v[120:123], v[216:219], v[56:59], v[120:123]
    v_mfma_f32_16x16x32_bf16 v[124:127], v[220:223], v[56:59], v[124:127]
    s_waitcnt vmcnt(14)
    v_mfma_f32_16x16x32_bf16 v[112:115], v[224:227], v[60:63], v[112:115]
    v_mfma_f32_16x16x32_bf16 v[116:119], v[228:231], v[60:63], v[116:119]
    buffer_load_dwordx4 v[56:59], v1, s[56:59], s5 offen offset:3072 sc1
    v_mfma_f32_16x16x32_bf16 v[120:123], v[232:235], v[60:63], v[120:123]
    v_mfma_f32_16x16x32_bf16 v[124:127], v[236:239], v[60:63], v[124:127]
    s_waitcnt vmcnt(14)
    v_mfma_f32_16x16x32_bf16 v[112:115], v[240:243], v[64:67], v[112:115]
    v_mfma_f32_16x16x32_bf16 v[116:119], v[244:247], v[64:67], v[116:119]
    buffer_load_dwordx4 v[60:63], v1, s[56:59], s6 offen offset:3072 sc1
    v_mfma_f32_16x16x32_bf16 v[120:123], v[248:251], v[64:67], v[120:123]
    v_mfma_f32_16x16x32_bf16 v[124:127], v[252:255], v[64:67], v[124:127]
    v_mfma_f32_16x16x32_bf16 v[128:131], v[144:147], v[100:103], 0
    v_mfma_f32_16x16x32_bf16 v[132:135], v[148:151], v[100:103], 0
    buffer_load_dwordx4 v[64:67], v1, s[56:59], s7 offen offset:3072 sc1
    v_mfma_f32_16x16x32_bf16 v[136:139], v[152:155], v[100:103], 0
    v_mfma_f32_16x16x32_bf16 v[140:143], v[156:159], v[100:103], 0
    s_nop 0
    ds_write_b128 v2, v[112:115] offset:16384
    s_waitcnt vmcnt(15)
    v_mfma_f32_16x16x32_bf16 v[128:131], v[160:163], v[68:71], v[128:131]
    ds_write_b128 v2, v[116:119] offset:17408
    v_mfma_f32_16x16x32_bf16 v[132:135], v[164:167], v[68:71], v[132:135]
    ds_write_b128 v2, v[120:123] offset:18432
    v_mfma_f32_16x16x32_bf16 v[136:139], v[168:171], v[68:71], v[136:139]
    ds_write_b128 v2, v[124:127] offset:19456
    v_mfma_f32_16x16x32_bf16 v[140:143], v[172:175], v[68:71], v[140:143]
    ds_write_b32 v3, v3 offset:160
    s_waitcnt vmcnt(14)
    v_mfma_f32_16x16x32_bf16 v[128:131], v[176:179], v[72:75], v[128:131]
    v_mfma_f32_16x16x32_bf16 v[132:135], v[180:183], v[72:75], v[132:135]
    buffer_load_dwordx4 v[68:71], v1, s[56:59], s8 offen offset:3072 sc1
    v_mfma_f32_16x16x32_bf16 v[136:139], v[184:187], v[72:75], v[136:139]
    v_mfma_f32_16x16x32_bf16 v[140:143], v[188:191], v[72:75], v[140:143]
    s_waitcnt vmcnt(14)
    v_mfma_f32_16x16x32_bf16 v[128:131], v[192:195], v[12:15], v[128:131]
    v_mfma_f32_16x16x32_bf16 v[132:135], v[196:199], v[12:15], v[132:135]
    buffer_load_dwordx4 v[72:75], v1, s[56:59], s9 offen offset:3072 sc1
    v_mfma_f32_16x16x32_bf16 v[136:139], v[200:203], v[12:15], v[136:139]
    v_mfma_f32_16x16x32_bf16 v[140:143], v[204:207], v[12:15], v[140:143]
    s_waitcnt vmcnt(14)
    v_mfma_f32_16x16x32_bf16 v[128:131], v[208:211], v[16:19], v[128:131]
    v_mfma_f32_16x16x32_bf16 v[132:135], v[212:215], v[16:19], v[132:135]
    v_mfma_f32_16x16x32_bf16 v[136:139], v[216:219], v[16:19], v[136:139]
    v_mfma_f32_16x16x32_bf16 v[140:143], v[220:223], v[16:19], v[140:143]
    s_waitcnt vmcnt(13)
    v_mfma_f32_16x16x32_bf16 v[128:131], v[224:227], v[20:23], v[128:131]
    v_mfma_f32_16x16x32_bf16 v[132:135], v[228:231], v[20:23], v[132:135]
    v_mfma_f32_16x16x32_bf16 v[136:139], v[232:235], v[20:23], v[136:139]
    v_mfma_f32_16x16x32_bf16 v[140:143], v[236:239], v[20:23], v[140:143]
    s_waitcnt vmcnt(12)
    v_mfma_f32_16x16x32_bf16 v[128:131], v[240:243], v[24:27], v[128:131]
    v_mfma_f32_16x16x32_bf16 v[132:135], v[244:247], v[24:27], v[132:135]
    v_mfma_f32_16x16x32_bf16 v[136:139], v[248:251], v[24:27], v[136:139]
    v_mfma_f32_16x16x32_bf16 v[140:143], v[252:255], v[24:27], v[140:143]
    v_mfma_f32_16x16x32_bf16 v[112:115], v[144:147], v[104:107], 0
    v_mfma_f32_16x16x32_bf16 v[116:119], v[148:151], v[104:107], 0
    v_mfma_f32_16x16x32_bf16 v[120:123], v[152:155], v[104:107], 0
    v_mfma_f32_16x16x32_bf16 v[124:127], v[156:159], v[104:107], 0
    s_nop 0
    ds_write_b128 v2, v[128:131] offset:24576
    s_waitcnt vmcnt(11)
    v_mfma_f32_16x16x32_bf16 v[112:115], v[160:163], v[28:31], v[112:115]
    ds_write_b128 v2, v[132:135] offset:25600
    v_mfma_f32_16x16x32_bf16 v[116:119], v[164:167], v[28:31], v[116:119]
    ds_write_b128 v2, v[136:139] offset:26624
    v_mfma_f32_16x16x32_bf16 v[120:123], v[168:171], v[28:31], v[120:123]
    ds_write_b128 v2, v[140:143] offset:27648
    v_mfma_f32_16x16x32_bf16 v[124:127], v[172:175], v[28:31], v[124:127]
    ds_write_b32 v3, v3 offset:176
    s_waitcnt vmcnt(10)
    v_mfma_f32_16x16x32_bf16 v[112:115], v[176:179], v[32:35], v[112:115]
    ds_read_b32 v80, v3 offset:16
    v_mfma_f32_16x16x32_bf16 v[116:119], v[180:183], v[32:35], v[116:119]
    v_mfma_f32_16x16x32_bf16 v[120:123], v[184:187], v[32:35], v[120:123]
    v_mfma_f32_16x16x32_bf16 v[124:127], v[188:191], v[32:35], v[124:127]
    s_waitcnt vmcnt(9)
    v_mfma_f32_16x16x32_bf16 v[112:115], v[192:195], v[36:39], v[112:115]
    v_mfma_f32_16x16x32_bf16 v[116:119], v[196:199], v[36:39], v[116:119]
    v_mfma_f32_16x16x32_bf16 v[120:123], v[200:203], v[36:39], v[120:123]
    v_mfma_f32_16x16x32_bf16 v[124:127], v[204:207], v[36:39], v[124:127]
    s_waitcnt vmcnt(8)
    v_mfma_f32_16x16x32_bf16 v[112:115], v[208:211], v[40:43], v[112:115]
    v_mfma_f32_16x16x32_bf16 v[116:119], v[212:215], v[40:43], v[116:119]
    v_mfma_f32_16x16x32_bf16 v[120:123], v[216:219], v[40:43], v[120:123]
    v_mfma_f32_16x16x32_bf16 v[124:127], v[220:223], v[40:43], v[124:127]
    s_waitcnt vmcnt(7)
    v_mfma_f32_16x16x32_bf16 v[112:115], v[224:227], v[44:47], v[112:115]
    v_mfma_f32_16x16x32_bf16 v[116:119], v[228:231], v[44:47], v[116:119]
    v_mfma_f32_16x16x32_bf16 v[120:123], v[232:235], v[44:47], v[120:123]
    v_mfma_f32_16x16x32_bf16 v[124:127], v[236:239], v[44:47], v[124:127]
    s_waitcnt vmcnt(6)
    v_mfma_f32_16x16x32_bf16 v[112:115], v[240:243], v[48:51], v[112:115]
    v_mfma_f32_16x16x32_bf16 v[116:119], v[244:247], v[48:51], v[116:119]
    v_mfma_f32_16x16x32_bf16 v[120:123], v[248:251], v[48:51], v[120:123]
    v_mfma_f32_16x16x32_bf16 v[124:127], v[252:255], v[48:51], v[124:127]
    s_mov_b32 s83, 0
OBW_12:
    s_waitcnt lgkmcnt(0)
    v_cmp_eq_u32 vcc, 0, v80
    s_add_u32 s83, s83, 1
    s_cmp_gt_u32 s83, 800000
    s_cbranch_scc1 OBX_13
    s_cbranch_vccz OBX_13
    ds_read_b32 v80, v3 offset:16
    s_branch OBW_12
OBX_13:
    v_mfma_f32_16x16x32_bf16 v[128:131], v[144:147], v[108:111], 0
    v_mfma_f32_16x16x32_bf16 v[132:135], v[148:151], v[108:111], 0
    v_mfma_f32_16x16x32_bf16 v[136:139], v[152:155], v[108:111], 0
    v_mfma_f32_16x16x32_bf16 v[140:143], v[156:159], v[108:111], 0
    s_nop 0
    ds_write_b128 v2, v[112:115] offset:28672
    s_waitcnt vmcnt(5)
    v_mfma_f32_16x16x32_bf16 v[128:131], v[160:163], v[52:55], v[128:131]
    ds_write_b128 v2, v[116:119] offset:29696
    v_mfma_f32_16x16x32_bf16 v[132:135], v[164:167], v[52:55], v[132:135]
    ds_write_b128 v2, v[120:123] offset:30720
    v_mfma_f32_16x16x32_bf16 v[136:139], v[168:171], v[52:55], v[136:139]
    ds_write_b128 v2, v[124:127] offset:31744
    v_mfma_f32_16x16x32_bf16 v[140:143], v[172:175], v[52:55], v[140:143]
    ds_write_b32 v3, v3 offset:192
    s_waitcnt vmcnt(4)
    v_mfma_f32_16x16x32_bf16 v[128:131], v[176:179], v[56:59], v[128:131]
    v_mfma_f32_16x16x32_bf16 v[132:135], v[180:183], v[56:59], v[132:135]
    v_mfma_f32_16x16x32_bf16 v[136:139], v[184:187], v[56:59], v[136:139]
    v_mfma_f32_16x16x32_bf16 v[140:143], v[188:191], v[56:59], v[140:143]
    s_waitcnt vmcnt(3)
    v_mfma_f32_16x16x32_bf16 v[128:131], v[192:195], v[60:63], v[128:131]
    v_mfma_f32_16x16x32_bf16 v[132:135], v[196:199], v[60:63], v[132:135]
    v_mfma_f32_16x16x32_bf16 v[136:139], v[200:203], v[60:63], v[136:139]
    v_mfma_f32_16x16x32_bf16 v[140:143], v[204:207], v[60:63], v[140:143]
    s_waitcnt vmcnt(2)
    v_mfma_f32_16x16x32_bf16 v[128:131], v[208:211], v[64:67], v[128:131]
    v_mfma_f32_16x16x32_bf16 v[132:135], v[212:215], v[64:67], v[132:135]
    v_mfma_f32_16x16x32_bf16 v[136:139], v[216:219], v[64:67], v[136:139]
    v_mfma_f32_16x16x32_bf16 v[140:143], v[220:223], v[64:67], v[140:143]
    s_waitcnt vmcnt(1)
    v_mfma_f32_16x16x32_bf16 v[128:131], v[224:227], v[68:71], v[128:131]
    v_mfma_f32_16x16x32_bf16 v[132:135], v[228:231], v[68:71], v[132:135]
    v_mfma_f32_16x16x32_bf16 v[136:139], v[232:235], v[68:71], v[136:139]
    v_mfma_f32_16x16x32_bf16 v[140:143], v[236:239], v[68:71], v[140:143]
    s_waitcnt vmcnt(0)
    v_mfma_f32_16x16x32_bf16 v[128:131], v[240:243], v[72:75], v[128:131]
    v_mfma_f32_16x16x32_bf16 v[132:135], v[244:247], v[72:75], v[132:135]
    v_mfma_f32_16x16x32_bf16 v[136:139], v[248:251], v[72:75], v[136:139]
    v_mfma_f32_16x16x32_bf16 v[140:143], v[252:255], v[72:75], v[140:143]
    s_nop 4
    ds_write_b128 v2, v[128:131] offset:20480
    ds_write_b128 v2, v[132:135] offset:21504
    ds_write_b128 v2, v[136:139] offset:22528
    ds_write_b128 v2, v[140:143] offset:23552
    ds_write_b32 v3, v3 offset:208
    s_endpgm
.p2align 3
L_A:
    s_lshl_b32 s73, s69, 12
    s_add_u32 s73, s73, 524288
    s_lshl2_add_u32 s68, s79, s62
    s_lshl_b32 s72, s61, 16
    s_and_b32 s77, s60, 1
    s_lshr_b32 s78, s60, 1
    s_lshl1_add_u32 s76, s68, s67
    s_add_u32 s76, s76, s78
    v_and_b32 v84, 15, v1
    v_lshrrev_b32 v85, 4, v1
    v_mov_b32 v6, 0
    s_lshl4_add_u32 s80, s60, s67
    v_add_lshl_u32 v5, v84, s80, 3
    s_and_b32 s82, s76, 0xfffe
    s_lshl_b32 s82, s82, 1
    v_lshrrev_b32 v86, 5, v1
    v_mov_b32 v31, 158720
    v_lshlrev_b32 v7, 4, v1
    s_mul_i32 s80, s78, 12928
    s_add_u32 s80, s80, 131072
    v_lshl_add_u32 v2, v1, 2, s80
    ds_write_b32 v2, v6 offset:12416
    ds_write_b32 v2, v6 offset:12672
    v_lshl_add_u32 v3, v1, 2, v31
    ds_write_b32 v3, v6
    s_bfm_b64 exec, 16, 0
    ds_write_b32 v2, v6 offset:0
    s_bfm_b64 exec, 15, 0
    ds_write_b32 v2, v6 offset:4160
    s_mov_b64 exec, -1
    s_waitcnt lgkmcnt(0)
    global_load_dwordx2 v[252:253], v5, s[10:11]
    s_load_dword s70, s[26:27], s72
    s_load_dword s71, s[26:27], s73
    s_load_dword s84, s[14:15], s82
    s_lshl_b32 s82, s76, 12
    s_load_dword s91, s[12:13], s82
    s_mov_b32 s56, s26
    s_and_b32 s57, s27, 0xffff
    s_mov_b32 s58, 20971520
    s_mov_b32 s59, 0x20000
    s_mov_b32 s52, s22
    s_and_b32 s53, s23, 0xffff
    s_mov_b32 s54, 1835008
    s_mov_b32 s55, 0x20000
    v_bfe_u32 v3, v1, 1, 1
    s_lshl_b32 s81, s60, 1
    v_or_b32 v3, s81, v3
    v_bfe_u32 v4, v1, 3, 1
    v_xor_b32 v3, v3, v4
    v_lshlrev_b32 v3, 4, v3
    v_bfe_u32 v4, v1, 2, 2
    v_lshl_add_u32 v3, v4, 7, v3
    v_and_b32 v4, 1, v1
    v_lshl_add_u32 v3, v4, 3, v3
    v_lshl_add_u32 v248, v85, 15, v3
    v_xor_b32 v249, 544, v248
    v_xor_b32 v250, 1088, v248
    v_xor_b32 v251, 1632, v248
    v_xor_b32 v3, 3, v85
    v_and_b32 v4, 3, v84
    v_lshl_add_u32 v3, v3, 2, v4
    v_lshlrev_b32 v3, 4, v3
    v_lshrrev_b32 v4, 2, v84
    v_lshl_add_u32 v239, v4, 14, v3
    s_lshl4_add_u32 s80, s60, s67
    s_lshl_b32 s80, s80, 12
    s_lshl_b32 s81, s66, 1
    s_add_u32 s90, s80, s81
    s_add_u32 s90, s90, 3145728
    s_lshl_b32 s81, s69, 8
    s_sub_u32 s80, s80, s81
    s_add_u32 s93, s80, 1056512
    s_lshl_b32 s80, s60, 5
    s_add_u32 s80, s80, s69
    s_lshl_b32 s80, s80, 6
    s_add_u32 s80, s80, s72
    s_add_u32 s94, s80, 1024
    v_bfe_u32 v2, v1, 1, 3
    v_xor_b32 v3, v2, v85
    v_lshlrev_b32 v3, 4, v3
    v_lshl_add_u32 v3, v84, 7, v3
    s_lshl_b32 s80, s77, 16
    v_add_u32 v232, s80, v3
    v_xor_b32 v233, 64, v232
    s_lshl1_add_u32 s80, s63, s78
    s_lshl_b32 s80, s80, 15
    s_lshl_b32 s81, s77, 11
    s_add_u32 s80, s80, s81
    v_add_u32 v234, s80, v3
    v_xor_b32 v235, 64, v234
    v_lshrrev_b32 v2, 2, v84
    v_and_b32 v3, 1, v85
    v_lshl_add_u32 v4, v3, 2, v2
    s_lshl_b32 s80, s78, 2
    v_xor_b32 v4, s80, v4
    v_lshlrev_b32 v4, 5, v4
    v_lshl_add_u32 v2, v3, 3, v2
    v_lshl_add_u32 v4, v2, 8, v4
    v_and_b32 v2, 3, v84
    v_lshl_add_u32 v4, v2, 3, v4
    v_lshl_add_u32 v4, v86, 15, v4
    v_add_u32 v224, 4096, v4
    v_xor_b32 v225, 32, v224
    v_xor_b32 v226, 64, v224
    v_xor_b32 v227, 96, v224
    v_add_u32 v228, 0x10000, v224
    v_add_u32 v229, 0x10000, v225
    v_add_u32 v230, 0x10000, v226
    v_add_u32 v231, 0x10000, v227
    v_lshrrev_b32 v2, 1, v84
    v_cmp_eq_u32 s[32:33], v2, v86
    v_mov_b32 v3, 0x3f803f80
    v_and_b32 v4, 1, v84
    v_mul_u32_u24 v4, 0xaaaa, v4
    v_add_u32 v91, 0x4444, v4
    v_cndmask_b32 v92, 0, v3, s[32:33]
    v_cndmask_b32 v93, 0, v3, s[32:33]
    v_cndmask_b32 v94, 0, v3, s[32:33]
    v_cndmask_b32 v95, 0, v3, s[32:33]
    v_mov_b32 v64, 0
    v_mov_b32 v65, 0
    v_mov_b32 v66, 0
    v_mov_b32 v67, 0
    v_mov_b32 v68, 0
    v_mov_b32 v69, 0
    v_mov_b32 v70, 0
    v_mov_b32 v71, 0
    v_mov_b32 v72, 0
    v_mov_b32 v73, 0
    v_mov_b32 v74, 0
    v_mov_b32 v75, 0
    v_mov_b32 v76, 0
    v_mov_b32 v77, 0
    v_mov_b32 v78, 0
    v_mov_b32 v79, 0
    v_lshrrev_b32 v2, 1, v85
    s_lshl_b32 s80, s60, 1
    v_or_b32 v2, s80, v2
    v_lshlrev_b32 v2, 1, v2
    v_xor_b32 v2, v2, v84
    v_lshlrev_b32 v2, 3, v2
    v_lshl_add_u32 v2, v85, 7, v2
    s_lshl_b32 s80, s63, 16
    s_lshl_b32 s81, s60, 9
    s_add_u32 s80, s80, s81
    v_add_u32 v236, s80, v2
    v_mov_b32 v30, 1
    v_lshlrev_b32 v40, 6, v1
    v_lshlrev_b32 v41, 2, v1
    s_lshl_b32 s80, s77, 8
    s_add_u32 s80, s80, 157184
    v_add_u32 v51, s80, v7
    s_lshl_b32 s82, s60, 6
    s_add_u32 s82, s82, 157696
    v_lshl_add_u32 v56, v84, 2, s82
    v_lshrrev_b32 v2, 2, v84
    v_cmp_eq_u32 s[34:35], v2, v85
    v_and_b32 v2, 1, v84
    v_cmp_eq_u32 s[36:37], 1, v2
    v_and_b32 v2, 2, v84
    v_cmp_eq_u32 s[38:39], 2, v2
    s_lshr_b32 s80, s64, 6
    s_add_u32 s80, s80, s77
    s_mul_i32 s80, s80, 56
    s_lshl1_add_u32 s80, s78, s80
    s_lshr_b32 s81, s65, 5
    s_add_u32 s80, s80, s81
    s_lshl_b32 s80, s80, 12
    s_add_u32 s28, s80, 5242880
    s_add_u32 s29, s28, 4096
    s_lshl2_add_u32 s80, s61, s60
    s_lshl_b32 s80, s80, 6
    s_add_u32 s80, s80, s73
    s_add_u32 s86, s80, 128
    s_mov_b32 s95, 0xbb124925
    s_mul_i32 s80, s78, 12928
    s_lshl_b32 s81, s77, 8
    s_add_u32 s80, s80, s81
    s_add_u32 s80, s80, 131072
    v_mov_b32 v3, 4192
    v_mov_b32 v4, 34
    v_cndmask_b32 v2, v3, v4, s[36:37]
    v_lshl_add_u32 v2, v84, 1, v2
    v_lshl_add_u32 v2, v85, 4, v2
    v_add_u32 v12, s80, v2
    v_add_u32 v13, 1024, v12
    v_add_u32 v14, 2048, v12
    v_add_u32 v15, 3072, v12
    v_lshlrev_b32 v2, 5, v84
    v_lshlrev_b32 v3, 4, v85
    v_sub_u32 v2, v3, v2
    s_add_u32 s80, s80, 8800
    v_add_u32 v32, s80, v2
    s_lshl1_add_u32 s80, s76, s77
    s_lshl_b32 s80, s80, 11
    s_add_u32 s87, s80, 3145728
    s_sub_u32 s80, s76, s67
    s_lshl_b32 s81, s77, 6
    s_add_u32 s80, s80, s81
    s_lshl_b32 s80, s80, 6
    s_add_u32 s80, s80, s72
    s_add_u32 s88, s80, 32768
    s_lshr_b32 s80, s66, 10
    s_lshl_b32 s80, s80, 12
    s_add_u32 s80, s80, s72
    s_add_u32 s89, s80, 32768
    s_xor_b32 s80, s77, s63
    s_xor_b32 s80, s80, 1
    s_lshl4_add_u32 s80, s78, s80
    s_lshl_b32 s80, s80, 12
    s_add_u32 s80, s80, 16384
    v_add_u32 v49, s80, v7
    s_mul_i32 s80, s69, 7
    s_add_u32 s80, s80, s61
    s_lshl2_add_u32 s80, s80, s60
    s_lshl_b32 s80, s80, 12
    s_add_u32 s42, s80, 16777216
    s_xor_b32 s80, s69, 1
    s_mul_i32 s80, s80, 7
    s_add_u32 s80, s80, s61
    s_lshl2_add_u32 s80, s80, s60
    s_lshl_b32 s80, s80, 12
    s_add_u32 s43, s80, 16777216
    s_mov_b32 s44, 0x5030201
    s_mov_b32 s45, 0x6050302
    s_mov_b32 s46, 0x7060503
    s_mov_b32 s47, 0x201000c
    s_mov_b32 s48, 0x504030c
    s_mov_b32 s49, 0x403020c
    s_mov_b32 s50, 0x302010c
    s_add_u32 s80, s75, 20480
    v_add_u32 v34, s80, v7
    v_xor_b32 v33, 0x8000, v34
    v_lshlrev_b32 v4, 5, v84
    v_lshl_add_u32 v4, v85, 3, v4
    v_bfe_u32 v3, v84, 2, 1
    v_lshlrev_b32 v3, 4, v3
    v_xor_b32 v4, v4, v3
    v_add_u32 v35, s80, v4
    v_bfe_u32 v3, v1, 3, 1
    v_lshlrev_b32 v3, 4, v3
    v_xor_b32 v48, v7, v3
    s_lshl2_add_u32 s81, s78, 158720
    v_mov_b32 v36, s81
    s_lshl2_add_u32 s80, s60, 158752
    v_mov_b32 v38, s80
    v_and_b32 v39, 3, v1
    v_lshl_add_u32 v39, v39, 2, v31
    v_and_b32 v2, 3, v84
    v_lshl_add_u32 v2, v2, 4, v85
    s_lshl_b32 s80, s60, 4
    s_add_u32 s81, s80, 157696
    v_lshl_add_u32 v47, v2, 2, s81
    s_lshl2_add_u32 s80, s63, s60
    s_lshl_b32 s80, s80, 6
    s_add_u32 s80, s80, 157184
    v_and_b32 v2, 3, v84
    v_lshl_add_u32 v2, v85, 2, v2
    v_lshl_add_u32 v46, v2, 2, s80
    v_mul_u32_u24 v2, 896, v85
    v_lshl_add_u32 v37, v84, 3, v2
    v_lshrrev_b32 v2, 3, v84
    v_and_b32 v3, 1, v84
    v_lshl_add_u32 v2, v2, 1, v3
    v_xor_b32 v3, s60, v2
    v_lshl_add_u32 v3, v3, 2, v85
    v_lshlrev_b32 v3, 4, v3
    v_lshl_add_u32 v2, v2, 8, v3
    v_bfe_u32 v3, v84, 1, 2
    v_lshl_add_u32 v42, v3, 10, v2
    v_add_u32 v43, 0x10000, v42
    v_and_b32 v2, 7, v84
    v_lshlrev_b32 v3, 9, v84
    v_lshl_add_u32 v3, v85, 1, v3
    s_lshl_b32 s80, s77, 3
    s_add_u32 s80, s80, 131072
    v_add_u32 v3, s80, v3
    v_xor_b32 v4, s78, v2
    v_lshl_add_u32 v24, v4, 4, v3
    v_xor_b32 v25, 32, v24
    v_xor_b32 v26, 64, v24
    v_xor_b32 v27, 96, v24
    s_lshl2_add_u32 s80, s60, s66
    s_mul_i32 s80, s80, 896
    s_lshl1_add_u32 s96, s67, s80
    s_add_u32 s97, s96, 14336
    s_add_u32 s98, s96, 28672
    s_add_u32 s99, s96, 43008
    s_lshl_b32 s80, s77, 2
    v_or_b32 v2, s80, v86
    v_and_b32 v3, 7, v1
    v_xor_b32 v2, v2, v3
    v_lshrrev_b32 v3, 3, v1
    v_lshlrev_b32 v3, 12, v3
    v_lshl_add_u32 v44, v2, 4, v3
    v_xor_b32 v3, 32, v44
    v_add_u32 v45, 31744, v3
    s_lshl_b32 s80, s60, 11
    s_add_u32 m0, s80, 131072
    s_waitcnt lgkmcnt(0)
    s_mul_i32 s80, s78, 12928
    s_add_u32 s80, s80, 135292
    s_lshl_b32 s81, s91, 16
    v_mov_b32 v2, s80
    v_mov_b32 v3, s81
    s_cmp_lg_u32 s77, 0
    s_cbranch_scc1 PT_14
    ds_write_b32 v2, v3
PT_14:
    s_add_u32 s70, s70, 2654435769
    s_add_u32 s71, s71, 2654435769
    v_mov_b32 v28, s70
    v_mov_b32 v29, s71
    s_lshl_b32 s80, s78, 4
    s_lshr_b32 s80, s84, s80
    s_and_b32 s80, s80, 0xffff
    s_cmp_eq_u32 s77, 0
    s_cselect_b32 s80, s80, 0
    v_xor_b32 v2, 15, v84
    v_and_b32 v3, 1, v2
    v_lshlrev_b32 v3, 4, v3
    v_lshlrev_b32 v3, v3, s80
    v_lshrrev_b32 v2, 1, v2
    v_lshlrev_b32 v4, 2, v85
    v_sub_u32 v2, v2, v4
    v_cmp_eq_u32 vcc, 0, v2
    s_nop 1
    v_cndmask_b32 v8, 0, v3, vcc
    v_cmp_eq_u32 vcc, 1, v2
    s_nop 1
    v_cndmask_b32 v9, 0, v3, vcc
    v_cmp_eq_u32 vcc, 2, v2
    s_nop 1
    v_cndmask_b32 v10, 0, v3, vcc
    v_cmp_eq_u32 vcc, 3, v2
    s_nop 1
    v_cndmask_b32 v11, 0, v3, vcc
    v_not_b32 v3, v28
    s_bfm_b64 exec, 16, 0
    buffer_store_dword v3, v41, s[56:59], s94 offen sc1
    s_mov_b64 exec, -1
    s_setprio 2
    s_waitcnt lgkmcnt(0)
    s_barrier
    ds_read_b128 v[176:179], v232 offset:0
    ds_read_b64_tr_b16 v[160:161], v224 offset:0
    ds_read_b64_tr_b16 v[162:163], v224 offset:1024
    ds_read_b128 v[180:183], v232 offset:2048
    ds_read_b64_tr_b16 v[164:165], v225 offset:0
    ds_read_b64_tr_b16 v[166:167], v225 offset:1024
    ds_read_b128 v[184:187], v232 offset:32768
    ds_read_b64_tr_b16 v[168:169], v226 offset:0
    ds_read_b64_tr_b16 v[170:171], v226 offset:1024
    ds_read_b128 v[188:191], v232 offset:34816
    ds_read_b64_tr_b16 v[172:173], v227 offset:0
    ds_read_b64_tr_b16 v[174:175], v227 offset:1024
    ds_read_b128 v[240:243], v234 offset:0
    s_waitcnt lgkmcnt(0)
    s_cmp_lg_u32 s61, 0
    s_cbranch_scc1 XC_15
    ds_read_b64 v[16:17], v236 offset:0
    ds_read_b64 v[18:19], v236 offset:2048
    ds_read_b64 v[20:21], v236 offset:32768
    ds_read_b64 v[22:23], v236 offset:34816
XC_15:
    v_mfma_f32_16x16x32_bf16 v[96:99], v[160:163], v[176:179], 0
    ds_read_b128 v[208:211], v233 offset:0
    v_mfma_f32_16x16x32_bf16 v[100:103], v[160:163], v[180:183], 0
    ds_read_b64_tr_b16 v[192:193], v228 offset:0
    v_mfma_f32_16x16x32_bf16 v[104:107], v[160:163], v[184:187], 0
    ds_read_b64_tr_b16 v[194:195], v228 offset:1024
    v_mfma_f32_16x16x32_bf16 v[108:111], v[160:163], v[188:191], 0
    ds_read_b128 v[212:215], v233 offset:2048
    v_mfma_f32_16x16x32_bf16 v[112:115], v[164:167], v[176:179], 0
    ds_read_b64_tr_b16 v[196:197], v229 offset:0
    v_mfma_f32_16x16x32_bf16 v[116:119], v[164:167], v[180:183], 0
    ds_read_b64_tr_b16 v[198:199], v229 offset:1024
    v_mfma_f32_16x16x32_bf16 v[120:123], v[164:167], v[184:187], 0
    ds_read_b128 v[216:219], v233 offset:32768
    v_mfma_f32_16x16x32_bf16 v[124:127], v[164:167], v[188:191], 0
    ds_read_b64_tr_b16 v[200:201], v230 offset:0
    v_mfma_f32_16x16x32_bf16 v[128:131], v[168:171], v[176:179], 0
    ds_read_b64_tr_b16 v[202:203], v230 offset:1024
    v_mfma_f32_16x16x32_bf16 v[132:135], v[168:171], v[180:183], 0
    ds_read_b128 v[220:223], v233 offset:34816
    v_mfma_f32_16x16x32_bf16 v[136:139], v[168:171], v[184:187], 0
    ds_read_b64_tr_b16 v[204:205], v231 offset:0
    v_mfma_f32_16x16x32_bf16 v[140:143], v[168:171], v[188:191], 0
    ds_read_b64_tr_b16 v[206:207], v231 offset:1024
    v_mfma_f32_16x16x32_bf16 v[144:147], v[172:175], v[176:179], 0
    ds_read_b128 v[244:247], v235 offset:0
    v_mfma_f32_16x16x32_bf16 v[148:151], v[172:175], v[180:183], 0
    v_mfma_f32_16x16x32_bf16 v[152:155], v[172:175], v[184:187], 0
    v_mfma_f32_16x16x32_bf16 v[156:159], v[172:175], v[188:191], 0
    v_mfma_f32_16x16x32_bf16 v[80:83], v[240:243], v[240:243], 0
    v_smfmac_f32_16x16x64_bf16 v[64:67], v[92:95], v[160:167], v91
    v_smfmac_f32_16x16x64_bf16 v[68:71], v[92:95], v[168:175], v91
    v_smfmac_f32_16x16x64_bf16 v[72:75], v[92:95], v[176:183], v91
    v_smfmac_f32_16x16x64_bf16 v[76:79], v[92:95], v[184:191], v91
    s_waitcnt lgkmcnt(0)
    s_barrier
    v_mfma_f32_16x16x32_bf16 v[96:99], v[192:195], v[208:211], v[96:99]
    ds_read_b128 v[176:179], v232 offset:8192
    v_mfma_f32_16x16x32_bf16 v[100:103], v[192:195], v[212:215], v[100:103]
    ds_read_b64_tr_b16 v[160:161], v224 offset:8192
    v_mfma_f32_16x16x32_bf16 v[104:107], v[192:195], v[216:219], v[104:107]
    ds_read_b64_tr_b16 v[162:163], v224 offset:9216
    v_mfma_f32_16x16x32_bf16 v[108:111], v[192:195], v[220:223], v[108:111]
    ds_read_b128 v[180:183], v232 offset:10240
    v_mfma_f32_16x16x32_bf16 v[112:115], v[196:199], v[208:211], v[112:115]
    ds_read_b64_tr_b16 v[164:165], v225 offset:8192
    v_mfma_f32_16x16x32_bf16 v[116:119], v[196:199], v[212:215], v[116:119]
    ds_read_b64_tr_b16 v[166:167], v225 offset:9216
    v_mfma_f32_16x16x32_bf16 v[120:123], v[196:199], v[216:219], v[120:123]
    ds_read_b128 v[184:187], v232 offset:40960
    v_mfma_f32_16x16x32_bf16 v[124:127], v[196:199], v[220:223], v[124:127]
    ds_read_b64_tr_b16 v[168:169], v226 offset:8192
    v_mfma_f32_16x16x32_bf16 v[128:131], v[200:203], v[208:211], v[128:131]
    ds_read_b64_tr_b16 v[170:171], v226 offset:9216
    v_mfma_f32_16x16x32_bf16 v[132:135], v[200:203], v[212:215], v[132:135]
    ds_read_b128 v[188:191], v232 offset:43008
    v_mfma_f32_16x16x32_bf16 v[136:139], v[200:203], v[216:219], v[136:139]
    ds_read_b64_tr_b16 v[172:173], v227 offset:8192
    v_mfma_f32_16x16x32_bf16 v[140:143], v[200:203], v[220:223], v[140:143]
    ds_read_b64_tr_b16 v[174:175], v227 offset:9216
    v_mfma_f32_16x16x32_bf16 v[144:147], v[204:207], v[208:211], v[144:147]
    ds_read_b128 v[240:243], v234 offset:8192
    v_mfma_f32_16x16x32_bf16 v[148:151], v[204:207], v[212:215], v[148:151]
    v_mfma_f32_16x16x32_bf16 v[152:155], v[204:207], v[216:219], v[152:155]
    v_mfma_f32_16x16x32_bf16 v[156:159], v[204:207], v[220:223], v[156:159]
    v_mfma_f32_16x16x32_bf16 v[80:83], v[244:247], v[244:247], v[80:83]
    v_smfmac_f32_16x16x64_bf16 v[64:67], v[92:95], v[192:199], v91
    v_smfmac_f32_16x16x64_bf16 v[68:71], v[92:95], v[200:207], v91
    v_smfmac_f32_16x16x64_bf16 v[72:75], v[92:95], v[208:215], v91
    v_smfmac_f32_16x16x64_bf16 v[76:79], v[92:95], v[216:223], v91
    s_waitcnt lgkmcnt(0)
    s_cmp_lg_u32 s61, 1
    s_cbranch_scc1 XC_16
    ds_read_b64 v[16:17], v236 offset:8192
    ds_read_b64 v[18:19], v236 offset:10240
    ds_read_b64 v[20:21], v236 offset:40960
    ds_read_b64 v[22:23], v236 offset:43008
XC_16:
    v_mfma_f32_16x16x32_bf16 v[96:99], v[160:163], v[176:179], v[96:99]
    ds_read_b128 v[208:211], v233 offset:8192
    v_mfma_f32_16x16x32_bf16 v[100:103], v[160:163], v[180:183], v[100:103]
    ds_read_b64_tr_b16 v[192:193], v228 offset:8192
    v_mfma_f32_16x16x32_bf16 v[104:107], v[160:163], v[184:187], v[104:107]
    ds_read_b64_tr_b16 v[194:195], v228 offset:9216
    v_mfma_f32_16x16x32_bf16 v[108:111], v[160:163], v[188:191], v[108:111]
    ds_read_b128 v[212:215], v233 offset:10240
    v_mfma_f32_16x16x32_bf16 v[112:115], v[164:167], v[176:179], v[112:115]
    ds_read_b64_tr_b16 v[196:197], v229 offset:8192
    v_mfma_f32_16x16x32_bf16 v[116:119], v[164:167], v[180:183], v[116:119]
    ds_read_b64_tr_b16 v[198:199], v229 offset:9216
    v_mfma_f32_16x16x32_bf16 v[120:123], v[164:167], v[184:187], v[120:123]
    ds_read_b128 v[216:219], v233 offset:40960
    v_mfma_f32_16x16x32_bf16 v[124:127], v[164:167], v[188:191], v[124:127]
    ds_read_b64_tr_b16 v[200:201], v230 offset:8192
    v_mfma_f32_16x16x32_bf16 v[128:131], v[168:171], v[176:179], v[128:131]
    ds_read_b64_tr_b16 v[202:203], v230 offset:9216
    v_mfma_f32_16x16x32_bf16 v[132:135], v[168:171], v[180:183], v[132:135]
    ds_read_b128 v[220:223], v233 offset:43008
    v_mfma_f32_16x16x32_bf16 v[136:139], v[168:171], v[184:187], v[136:139]
    ds_read_b64_tr_b16 v[204:205], v231 offset:8192
    v_mfma_f32_16x16x32_bf16 v[140:143], v[168:171], v[188:191], v[140:143]
    ds_read_b64_tr_b16 v[206:207], v231 offset:9216
    v_mfma_f32_16x16x32_bf16 v[144:147], v[172:175], v[176:179], v[144:147]
    ds_read_b128 v[244:247], v235 offset:8192
    v_mfma_f32_16x16x32_bf16 v[148:151], v[172:175], v[180:183], v[148:151]
    v_mfma_f32_16x16x32_bf16 v[152:155], v[172:175], v[184:187], v[152:155]
    v_mfma_f32_16x16x32_bf16 v[156:159], v[172:175], v[188:191], v[156:159]
    v_mfma_f32_16x16x32_bf16 v[80:83], v[240:243], v[240:243], v[80:83]
    v_smfmac_f32_16x16x64_bf16 v[64:67], v[92:95], v[160:167], v91
    v_smfmac_f32_16x16x64_bf16 v[68:71], v[92:95], v[168:175], v91
    v_smfmac_f32_16x16x64_bf16 v[72:75], v[92:95], v[176:183], v91
    v_smfmac_f32_16x16x64_bf16 v[76:79], v[92:95], v[184:191], v91
    s_waitcnt lgkmcnt(0)
    v_mfma_f32_16x16x32_bf16 v[96:99], v[192:195], v[208:211], v[96:99]
    v_mfma_f32_16x16x32_bf16 v[100:103], v[192:195], v[212:215], v[100:103]
    v_mfma_f32_16x16x32_bf16 v[104:107], v[192:195], v[216:219], v[104:107]
    v_mfma_f32_16x16x32_bf16 v[108:111], v[192:195], v[220:223], v[108:111]
    v_mfma_f32_16x16x32_bf16 v[112:115], v[196:199], v[208:211], v[112:115]
    v_mfma_f32_16x16x32_bf16 v[116:119], v[196:199], v[212:215], v[116:119]
    v_mfma_f32_16x16x32_bf16 v[120:123], v[196:199], v[216:219], v[120:123]
    v_mfma_f32_16x16x32_bf16 v[124:127], v[196:199], v[220:223], v[124:127]
    v_mfma_f32_16x16x32_bf16 v[128:131], v[200:203], v[208:211], v[128:131]
    v_mfma_f32_16x16x32_bf16 v[132:135], v[200:203], v[212:215], v[132:135]
    v_mfma_f32_16x16x32_bf16 v[136:139], v[200:203], v[216:219], v[136:139]
    v_mfma_f32_16x16x32_bf16 v[140:143], v[200:203], v[220:223], v[140:143]
    v_mfma_f32_16x16x32_bf16 v[144:147], v[204:207], v[208:211], v[144:147]
    v_mfma_f32_16x16x32_bf16 v[148:151], v[204:207], v[212:215], v[148:151]
    v_mfma_f32_16x16x32_bf16 v[152:155], v[204:207], v[216:219], v[152:155]
    v_mfma_f32_16x16x32_bf16 v[156:159], v[204:207], v[220:223], v[156:159]
    v_mfma_f32_16x16x32_bf16 v[80:83], v[244:247], v[244:247], v[80:83]
    v_smfmac_f32_16x16x64_bf16 v[64:67], v[92:95], v[192:199], v91
    v_smfmac_f32_16x16x64_bf16 v[68:71], v[92:95], v[200:207], v91
    v_smfmac_f32_16x16x64_bf16 v[72:75], v[92:95], v[208:215], v91
    v_smfmac_f32_16x16x64_bf16 v[76:79], v[92:95], v[216:223], v91
    s_waitcnt vmcnt(0)
    v_alignbit_b32 v252, v252, v252, 16
    v_alignbit_b32 v253, v253, v253, 16
    s_barrier
    ds_read_b64_tr_b16 v[160:161], v249 offset:28672
    ds_read_b64_tr_b16 v[162:163], v248 offset:24576
    ds_read_b64_tr_b16 v[164:165], v249 offset:24576
    ds_read_b64_tr_b16 v[166:167], v250 offset:24576
    ds_read_b64_tr_b16 v[168:169], v251 offset:24576
    ds_read_b64_tr_b16 v[172:173], v248 offset:26624
    ds_read_b64_tr_b16 v[174:175], v249 offset:26624
    ds_read_b64_tr_b16 v[176:177], v250 offset:26624
    ds_read_b64_tr_b16 v[178:179], v251 offset:26624
    s_waitcnt lgkmcnt(4)
.p2align 3
    v_alignbit_b32 v180, v161, v160, 16
    v_alignbit_b32 v181, v162, v161, 16
    v_alignbit_b32 v182, v163, v162, 16
    v_alignbit_b32 v183, v164, v163, 16
    v_alignbit_b32 v184, v165, v164, 16
    v_alignbit_b32 v185, v166, v165, 16
    v_alignbit_b32 v186, v167, v166, 16
    v_alignbit_b32 v187, v168, v167, 16
    v_alignbit_b32 v188, v169, v168, 16
    v_dot2_f32_bf16 v193, v162, v252, 0
    v_dot2_f32_bf16 v192, v181, v252, 0
    v_dot2_f32_bf16 v195, v163, v252, 0
    v_dot2_f32_bf16 v194, v182, v252, 0
    v_dot2_f32_bf16 v197, v164, v252, 0
    v_dot2_f32_bf16 v196, v183, v252, 0
    v_dot2_f32_bf16 v199, v165, v252, 0
    v_dot2_f32_bf16 v198, v184, v252, 0
    v_dot2_f32_bf16 v201, v166, v252, 0
    v_dot2_f32_bf16 v200, v185, v252, 0
    v_dot2_f32_bf16 v203, v167, v252, 0
    v_dot2_f32_bf16 v202, v186, v252, 0
    v_dot2_f32_bf16 v205, v168, v252, 0
    v_dot2_f32_bf16 v204, v187, v252, 0
    v_dot2_f32_bf16 v207, v169, v252, 0
    v_dot2_f32_bf16 v206, v188, v252, 0
    v_dot2_f32_bf16 v193, v161, v253, v193
    v_dot2_f32_bf16 v192, v180, v253, v192
    v_dot2_f32_bf16 v195, v162, v253, v195
    v_dot2_f32_bf16 v194, v181, v253, v194
    v_dot2_f32_bf16 v197, v163, v253, v197
    v_dot2_f32_bf16 v196, v182, v253, v196
    v_dot2_f32_bf16 v199, v164, v253, v199
    v_dot2_f32_bf16 v198, v183, v253, v198
    v_dot2_f32_bf16 v201, v165, v253, v201
    v_dot2_f32_bf16 v200, v184, v253, v200
    v_dot2_f32_bf16 v203, v166, v253, v203
    v_dot2_f32_bf16 v202, v185, v253, v202
    v_dot2_f32_bf16 v205, v167, v253, v205
    v_dot2_f32_bf16 v204, v186, v253, v204
    v_dot2_f32_bf16 v207, v168, v253, v207
    v_dot2_f32_bf16 v206, v187, v253, v206
    s_waitcnt lgkmcnt(0)
    v_lshlrev_b32 v180, 16, v172
    v_and_b32 v172, 0xffff0000, v172
    v_lshlrev_b32 v181, 16, v173
    v_and_b32 v173, 0xffff0000, v173
    v_lshlrev_b32 v182, 16, v174
    v_and_b32 v174, 0xffff0000, v174
    v_lshlrev_b32 v183, 16, v175
    v_and_b32 v175, 0xffff0000, v175
    v_lshlrev_b32 v184, 16, v176
    v_and_b32 v176, 0xffff0000, v176
    v_lshlrev_b32 v185, 16, v177
    v_and_b32 v177, 0xffff0000, v177
    v_lshlrev_b32 v186, 16, v178
    v_and_b32 v178, 0xffff0000, v178
    v_lshlrev_b32 v187, 16, v179
    v_and_b32 v179, 0xffff0000, v179
    v_mul_f32 v192, v192, v180
    v_mul_f32 v193, v193, v172
    v_mul_f32 v194, v194, v181
    v_mul_f32 v195, v195, v173
    v_mul_f32 v196, v196, v182
    v_mul_f32 v197, v197, v174
    v_mul_f32 v198, v198, v183
    v_mul_f32 v199, v199, v175
    v_mul_f32 v200, v200, v184
    v_mul_f32 v201, v201, v176
    v_mul_f32 v202, v202, v185
    v_mul_f32 v203, v203, v177
    v_mul_f32 v204, v204, v186
    v_mul_f32 v205, v205, v178
    v_mul_f32 v206, v206, v187
    v_mul_f32 v207, v207, v179
    v_cvt_pk_bf16_f32 v208, v207, v206
    v_cvt_pk_bf16_f32 v209, v205, v204
    v_cvt_pk_bf16_f32 v210, v203, v202
    v_cvt_pk_bf16_f32 v211, v201, v200
    v_cvt_pk_bf16_f32 v212, v199, v198
    v_cvt_pk_bf16_f32 v213, v197, v196
    v_cvt_pk_bf16_f32 v214, v195, v194
    v_cvt_pk_bf16_f32 v215, v193, v192
    s_add_u32 s80, s93, 8192
    s_nop 0
    v_mov_b32_dpp v192, v208 quad_perm:[2,3,0,1] row_mask:0xf bank_mask:0xf
    v_mov_b32_dpp v193, v209 quad_perm:[2,3,0,1] row_mask:0xf bank_mask:0xf
    v_mov_b32_dpp v194, v210 quad_perm:[2,3,0,1] row_mask:0xf bank_mask:0xf
    v_mov_b32_dpp v195, v211 quad_perm:[2,3,0,1] row_mask:0xf bank_mask:0xf
    v_mov_b32_dpp v196, v212 quad_perm:[2,3,0,1] row_mask:0xf bank_mask:0xf
    v_mov_b32_dpp v197, v213 quad_perm:[2,3,0,1] row_mask:0xf bank_mask:0xf
    v_mov_b32_dpp v198, v214 quad_perm:[2,3,0,1] row_mask:0xf bank_mask:0xf
    v_mov_b32_dpp v199, v215 quad_perm:[2,3,0,1] row_mask:0xf bank_mask:0xf
    v_cndmask_b32 v248, v208, v196, s[38:39]
    v_cndmask_b32 v249, v209, v197, s[38:39]
    v_cndmask_b32 v250, v210, v198, s[38:39]
    v_cndmask_b32 v251, v211, v199, s[38:39]
    v_cndmask_b32 v252, v192, v212, s[38:39]
    v_cndmask_b32 v253, v193, v213, s[38:39]
    v_cndmask_b32 v254, v194, v214, s[38:39]
    v_cndmask_b32 v255, v195, v215, s[38:39]
    buffer_store_dwordx4 v[248:251], v239, s[56:59], s93 offen sc1
    buffer_store_dwordx4 v[252:255], v239, s[56:59], s80 offen sc1
    v_not_b32 v2, v29
    v_not_b32 v3, v28
    s_bfm_b64 exec, 16, 0
    buffer_store_dword v2, v41, s[56:59], s86 offen sc1
    buffer_store_dword v3, v41, s[56:59], s88 offen sc1
    s_mov_b64 exec, -1
    s_waitcnt lgkmcnt(0)
    s_barrier
    ds_read_b128 v[176:179], v232 offset:16384
    ds_read_b64_tr_b16 v[160:161], v224 offset:16384
    ds_read_b64_tr_b16 v[162:163], v224 offset:17408
    ds_read_b128 v[180:183], v232 offset:18432
    ds_read_b64_tr_b16 v[164:165], v225 offset:16384
    ds_read_b64_tr_b16 v[166:167], v225 offset:17408
    ds_read_b128 v[184:187], v232 offset:49152
    ds_read_b64_tr_b16 v[168:169], v226 offset:16384
    ds_read_b64_tr_b16 v[170:171], v226 offset:17408
    ds_read_b128 v[188:191], v232 offset:51200
    ds_read_b64_tr_b16 v[172:173], v227 offset:16384
    ds_read_b64_tr_b16 v[174:175], v227 offset:17408
    ds_read_b128 v[240:243], v234 offset:16384
    s_waitcnt lgkmcnt(0)
    s_cmp_lg_u32 s61, 2
    s_cbranch_scc1 XC_17
    ds_read_b64 v[16:17], v236 offset:16384
    ds_read_b64 v[18:19], v236 offset:18432
    ds_read_b64 v[20:21], v236 offset:49152
    ds_read_b64 v[22:23], v236 offset:51200
XC_17:
    v_mfma_f32_16x16x32_bf16 v[96:99], v[160:163], v[176:179], v[96:99]
    ds_read_b128 v[208:211], v233 offset:16384
    v_mfma_f32_16x16x32_bf16 v[100:103], v[160:163], v[180:183], v[100:103]
    ds_read_b64_tr_b16 v[192:193], v228 offset:16384
    v_mfma_f32_16x16x32_bf16 v[104:107], v[160:163], v[184:187], v[104:107]
    ds_read_b64_tr_b16 v[194:195], v228 offset:17408
    v_mfma_f32_16x16x32_bf16 v[108:111], v[160:163], v[188:191], v[108:111]
    ds_read_b128 v[212:215], v233 offset:18432
    v_mfma_f32_16x16x32_bf16 v[112:115], v[164:167], v[176:179], v[112:115]
    ds_read_b64_tr_b16 v[196:197], v229 offset:16384
    v_mfma_f32_16x16x32_bf16 v[116:119], v[164:167], v[180:183], v[116:119]
    ds_read_b64_tr_b16 v[198:199], v229 offset:17408
    v_mfma_f32_16x16x32_bf16 v[120:123], v[164:167], v[184:187], v[120:123]
    ds_read_b128 v[216:219], v233 offset:49152
    v_mfma_f32_16x16x32_bf16 v[124:127], v[164:167], v[188:191], v[124:127]
    ds_read_b64_tr_b16 v[200:201], v230 offset:16384
    v_mfma_f32_16x16x32_bf16 v[128:131], v[168:171], v[176:179], v[128:131]
    ds_read_b64_tr_b16 v[202:203], v230 offset:17408
    v_mfma_f32_16x16x32_bf16 v[132:135], v[168:171], v[180:183], v[132:135]
    ds_read_b128 v[220:223], v233 offset:51200
    v_mfma_f32_16x16x32_bf16 v[136:139], v[168:171], v[184:187], v[136:139]
    ds_read_b64_tr_b16 v[204:205], v231 offset:16384
    v_mfma_f32_16x16x32_bf16 v[140:143], v[168:171], v[188:191], v[140:143]
    ds_read_b64_tr_b16 v[206:207], v231 offset:17408
    v_mfma_f32_16x16x32_bf16 v[144:147], v[172:175], v[176:179], v[144:147]
    ds_read_b128 v[244:247], v235 offset:16384
    v_mfma_f32_16x16x32_bf16 v[148:151], v[172:175], v[180:183], v[148:151]
    v_mfma_f32_16x16x32_bf16 v[152:155], v[172:175], v[184:187], v[152:155]
    v_mfma_f32_16x16x32_bf16 v[156:159], v[172:175], v[188:191], v[156:159]
    v_mfma_f32_16x16x32_bf16 v[80:83], v[240:243], v[240:243], v[80:83]
    v_smfmac_f32_16x16x64_bf16 v[64:67], v[92:95], v[160:167], v91
    v_smfmac_f32_16x16x64_bf16 v[68:71], v[92:95], v[168:175], v91
    v_smfmac_f32_16x16x64_bf16 v[72:75], v[92:95], v[176:183], v91
    v_smfmac_f32_16x16x64_bf16 v[76:79], v[92:95], v[184:191], v91
    s_waitcnt lgkmcnt(0)
    s_waitcnt vmcnt(0)
    s_bfm_b64 exec, 16, 0
    buffer_store_dword v28, v41, s[56:59], s94 offen sc1
    s_mov_b64 exec, -1
    s_barrier
    v_mfma_f32_16x16x32_bf16 v[96:99], v[192:195], v[208:211], v[96:99]
    ds_read_b128 v[176:179], v232 offset:0
    v_mfma_f32_16x16x32_bf16 v[100:103], v[192:195], v[212:215], v[100:103]
    ds_read_b64_tr_b16 v[160:161], v224 offset:0
    v_mfma_f32_16x16x32_bf16 v[104:107], v[192:195], v[216:219], v[104:107]
    ds_read_b64_tr_b16 v[162:163], v224 offset:1024
    v_mfma_f32_16x16x32_bf16 v[108:111], v[192:195], v[220:223], v[108:111]
    ds_read_b128 v[180:183], v232 offset:2048
    v_mfma_f32_16x16x32_bf16 v[112:115], v[196:199], v[208:211], v[112:115]
    ds_read_b64_tr_b16 v[164:165], v225 offset:0
    v_mfma_f32_16x16x32_bf16 v[116:119], v[196:199], v[212:215], v[116:119]
    ds_read_b64_tr_b16 v[166:167], v225 offset:1024
    v_mfma_f32_16x16x32_bf16 v[120:123], v[196:199], v[216:219], v[120:123]
    ds_read_b128 v[184:187], v232 offset:32768
    v_mfma_f32_16x16x32_bf16 v[124:127], v[196:199], v[220:223], v[124:127]
    ds_read_b64_tr_b16 v[168:169], v226 offset:0
    v_mfma_f32_16x16x32_bf16 v[128:131], v[200:203], v[208:211], v[128:131]
    ds_read_b64_tr_b16 v[170:171], v226 offset:1024
    v_mfma_f32_16x16x32_bf16 v[132:135], v[200:203], v[212:215], v[132:135]
    ds_read_b128 v[188:191], v232 offset:34816
    v_mfma_f32_16x16x32_bf16 v[136:139], v[200:203], v[216:219], v[136:139]
    ds_read_b64_tr_b16 v[172:173], v227 offset:0
    v_mfma_f32_16x16x32_bf16 v[140:143], v[200:203], v[220:223], v[140:143]
    ds_read_b64_tr_b16 v[174:175], v227 offset:1024
    v_mfma_f32_16x16x32_bf16 v[144:147], v[204:207], v[208:211], v[144:147]
    ds_read_b128 v[240:243], v234 offset:0
    v_mfma_f32_16x16x32_bf16 v[148:151], v[204:207], v[212:215], v[148:151]
    v_mfma_f32_16x16x32_bf16 v[152:155], v[204:207], v[216:219], v[152:155]
    v_mfma_f32_16x16x32_bf16 v[156:159], v[204:207], v[220:223], v[156:159]
    v_mfma_f32_16x16x32_bf16 v[80:83], v[244:247], v[244:247], v[80:83]
    v_smfmac_f32_16x16x64_bf16 v[64:67], v[92:95], v[192:199], v91
    v_smfmac_f32_16x16x64_bf16 v[68:71], v[92:95], v[200:207], v91
    v_smfmac_f32_16x16x64_bf16 v[72:75], v[92:95], v[208:215], v91
    v_smfmac_f32_16x16x64_bf16 v[76:79], v[92:95], v[216:223], v91
    s_waitcnt lgkmcnt(0)
    s_cmp_lg_u32 s61, 3
    s_cbranch_scc1 XC_18
    ds_read_b64 v[16:17], v236 offset:0
    ds_read_b64 v[18:19], v236 offset:2048
    ds_read_b64 v[20:21], v236 offset:32768
    ds_read_b64 v[22:23], v236 offset:34816
XC_18:
    v_mfma_f32_16x16x32_bf16 v[96:99], v[160:163], v[176:179], v[96:99]
    ds_read_b128 v[208:211], v233 offset:0
    v_mfma_f32_16x16x32_bf16 v[100:103], v[160:163], v[180:183], v[100:103]
    ds_read_b64_tr_b16 v[192:193], v228 offset:0
    v_mfma_f32_16x16x32_bf16 v[104:107], v[160:163], v[184:187], v[104:107]
    ds_read_b64_tr_b16 v[194:195], v228 offset:1024
    v_mfma_f32_16x16x32_bf16 v[108:111], v[160:163], v[188:191], v[108:111]
    ds_read_b128 v[212:215], v233 offset:2048
    v_mfma_f32_16x16x32_bf16 v[112:115], v[164:167], v[176:179], v[112:115]
    ds_read_b64_tr_b16 v[196:197], v229 offset:0
    v_mfma_f32_16x16x32_bf16 v[116:119], v[164:167], v[180:183], v[116:119]
    ds_read_b64_tr_b16 v[198:199], v229 offset:1024
    v_mfma_f32_16x16x32_bf16 v[120:123], v[164:167], v[184:187], v[120:123]
    ds_read_b128 v[216:219], v233 offset:32768
    v_mfma_f32_16x16x32_bf16 v[124:127], v[164:167], v[188:191], v[124:127]
    ds_read_b64_tr_b16 v[200:201], v230 offset:0
    v_mfma_f32_16x16x32_bf16 v[128:131], v[168:171], v[176:179], v[128:131]
    ds_read_b64_tr_b16 v[202:203], v230 offset:1024
    v_mfma_f32_16x16x32_bf16 v[132:135], v[168:171], v[180:183], v[132:135]
    ds_read_b128 v[220:223], v233 offset:34816
    v_mfma_f32_16x16x32_bf16 v[136:139], v[168:171], v[184:187], v[136:139]
    ds_read_b64_tr_b16 v[204:205], v231 offset:0
    v_mfma_f32_16x16x32_bf16 v[140:143], v[168:171], v[188:191], v[140:143]
    ds_read_b64_tr_b16 v[206:207], v231 offset:1024
    v_mfma_f32_16x16x32_bf16 v[144:147], v[172:175], v[176:179], v[144:147]
    ds_read_b128 v[244:247], v235 offset:0
    v_mfma_f32_16x16x32_bf16 v[148:151], v[172:175], v[180:183], v[148:151]
    v_mfma_f32_16x16x32_bf16 v[152:155], v[172:175], v[184:187], v[152:155]
    v_mfma_f32_16x16x32_bf16 v[156:159], v[172:175], v[188:191], v[156:159]
    v_mfma_f32_16x16x32_bf16 v[80:83], v[240:243], v[240:243], v[80:83]
    v_smfmac_f32_16x16x64_bf16 v[64:67], v[92:95], v[160:167], v91
    v_smfmac_f32_16x16x64_bf16 v[68:71], v[92:95], v[168:175], v91
    v_smfmac_f32_16x16x64_bf16 v[72:75], v[92:95], v[176:183], v91
    v_smfmac_f32_16x16x64_bf16 v[76:79], v[92:95], v[184:191], v91
    s_waitcnt lgkmcnt(0)
    s_barrier
    v_mfma_f32_16x16x32_bf16 v[96:99], v[192:195], v[208:211], v[96:99]
    ds_read_b128 v[176:179], v232 offset:8192
    v_mfma_f32_16x16x32_bf16 v[100:103], v[192:195], v[212:215], v[100:103]
    ds_read_b64_tr_b16 v[160:161], v224 offset:8192
    v_mfma_f32_16x16x32_bf16 v[104:107], v[192:195], v[216:219], v[104:107]
    ds_read_b64_tr_b16 v[162:163], v224 offset:9216
    v_mfma_f32_16x16x32_bf16 v[108:111], v[192:195], v[220:223], v[108:111]
    ds_read_b128 v[180:183], v232 offset:10240
    v_mfma_f32_16x16x32_bf16 v[112:115], v[196:199], v[208:211], v[112:115]
    ds_read_b64_tr_b16 v[164:165], v225 offset:8192
    v_mfma_f32_16x16x32_bf16 v[116:119], v[196:199], v[212:215], v[116:119]
    ds_read_b64_tr_b16 v[166:167], v225 offset:9216
    v_mfma_f32_16x16x32_bf16 v[120:123], v[196:199], v[216:219], v[120:123]
    ds_read_b128 v[184:187], v232 offset:40960
    v_mfma_f32_16x16x32_bf16 v[124:127], v[196:199], v[220:223], v[124:127]
    ds_read_b64_tr_b16 v[168:169], v226 offset:8192
    v_mfma_f32_16x16x32_bf16 v[128:131], v[200:203], v[208:211], v[128:131]
    ds_read_b64_tr_b16 v[170:171], v226 offset:9216
    v_mfma_f32_16x16x32_bf16 v[132:135], v[200:203], v[212:215], v[132:135]
    ds_read_b128 v[188:191], v232 offset:43008
    v_mfma_f32_16x16x32_bf16 v[136:139], v[200:203], v[216:219], v[136:139]
    ds_read_b64_tr_b16 v[172:173], v227 offset:8192
    v_mfma_f32_16x16x32_bf16 v[140:143], v[200:203], v[220:223], v[140:143]
    ds_read_b64_tr_b16 v[174:175], v227 offset:9216
    v_mfma_f32_16x16x32_bf16 v[144:147], v[204:207], v[208:211], v[144:147]
    ds_read_b128 v[240:243], v234 offset:8192
    v_mfma_f32_16x16x32_bf16 v[148:151], v[204:207], v[212:215], v[148:151]
    v_mfma_f32_16x16x32_bf16 v[152:155], v[204:207], v[216:219], v[152:155]
    v_mfma_f32_16x16x32_bf16 v[156:159], v[204:207], v[220:223], v[156:159]
    v_mfma_f32_16x16x32_bf16 v[80:83], v[244:247], v[244:247], v[80:83]
    v_smfmac_f32_16x16x64_bf16 v[64:67], v[92:95], v[192:199], v91
    v_smfmac_f32_16x16x64_bf16 v[68:71], v[92:95], v[200:207], v91
    v_smfmac_f32_16x16x64_bf16 v[72:75], v[92:95], v[208:215], v91
    v_smfmac_f32_16x16x64_bf16 v[76:79], v[92:95], v[216:223], v91
    s_waitcnt lgkmcnt(0)
    s_cmp_lg_u32 s61, 4
    s_cbranch_scc1 XC_19
    ds_read_b64 v[16:17], v236 offset:8192
    ds_read_b64 v[18:19], v236 offset:10240
    ds_read_b64 v[20:21], v236 offset:40960
    ds_read_b64 v[22:23], v236 offset:43008
XC_19:
    v_mfma_f32_16x16x32_bf16 v[96:99], v[160:163], v[176:179], v[96:99]
    ds_read_b128 v[208:211], v233 offset:8192
    v_mfma_f32_16x16x32_bf16 v[100:103], v[160:163], v[180:183], v[100:103]
    ds_read_b64_tr_b16 v[192:193], v228 offset:8192
    v_mfma_f32_16x16x32_bf16 v[104:107], v[160:163], v[184:187], v[104:107]
    ds_read_b64_tr_b16 v[194:195], v228 offset:9216
    v_mfma_f32_16x16x32_bf16 v[108:111], v[160:163], v[188:191], v[108:111]
    ds_read_b128 v[212:215], v233 offset:10240
    v_mfma_f32_16x16x32_bf16 v[112:115], v[164:167], v[176:179], v[112:115]
    ds_read_b64_tr_b16 v[196:197], v229 offset:8192
    v_mfma_f32_16x16x32_bf16 v[116:119], v[164:167], v[180:183], v[116:119]
    ds_read_b64_tr_b16 v[198:199], v229 offset:9216
    v_mfma_f32_16x16x32_bf16 v[120:123], v[164:167], v[184:187], v[120:123]
    ds_read_b128 v[216:219], v233 offset:40960
    v_mfma_f32_16x16x32_bf16 v[124:127], v[164:167], v[188:191], v[124:127]
    ds_read_b64_tr_b16 v[200:201], v230 offset:8192
    v_mfma_f32_16x16x32_bf16 v[128:131], v[168:171], v[176:179], v[128:131]
    ds_read_b64_tr_b16 v[202:203], v230 offset:9216
    v_mfma_f32_16x16x32_bf16 v[132:135], v[168:171], v[180:183], v[132:135]
    ds_read_b128 v[220:223], v233 offset:43008
    v_mfma_f32_16x16x32_bf16 v[136:139], v[168:171], v[184:187], v[136:139]
    ds_read_b64_tr_b16 v[204:205], v231 offset:8192
    v_mfma_f32_16x16x32_bf16 v[140:143], v[168:171], v[188:191], v[140:143]
    ds_read_b64_tr_b16 v[206:207], v231 offset:9216
    v_mfma_f32_16x16x32_bf16 v[144:147], v[172:175], v[176:179], v[144:147]
    ds_read_b128 v[244:247], v235 offset:8192
    v_mfma_f32_16x16x32_bf16 v[148:151], v[172:175], v[180:183], v[148:151]
    v_mfma_f32_16x16x32_bf16 v[152:155], v[172:175], v[184:187], v[152:155]
    v_mfma_f32_16x16x32_bf16 v[156:159], v[172:175], v[188:191], v[156:159]
    v_mfma_f32_16x16x32_bf16 v[80:83], v[240:243], v[240:243], v[80:83]
    v_smfmac_f32_16x16x64_bf16 v[64:67], v[92:95], v[160:167], v91
    v_smfmac_f32_16x16x64_bf16 v[68:71], v[92:95], v[168:175], v91
    v_smfmac_f32_16x16x64_bf16 v[72:75], v[92:95], v[176:183], v91
    v_smfmac_f32_16x16x64_bf16 v[76:79], v[92:95], v[184:191], v91
    s_waitcnt lgkmcnt(0)
    s_barrier
    v_mfma_f32_16x16x32_bf16 v[96:99], v[192:195], v[208:211], v[96:99]
    ds_read_b128 v[176:179], v232 offset:16384
    v_mfma_f32_16x16x32_bf16 v[100:103], v[192:195], v[212:215], v[100:103]
    ds_read_b64_tr_b16 v[160:161], v224 offset:16384
    v_mfma_f32_16x16x32_bf16 v[104:107], v[192:195], v[216:219], v[104:107]
    ds_read_b64_tr_b16 v[162:163], v224 offset:17408
    v_mfma_f32_16x16x32_bf16 v[108:111], v[192:195], v[220:223], v[108:111]
    ds_read_b128 v[180:183], v232 offset:18432
    v_mfma_f32_16x16x32_bf16 v[112:115], v[196:199], v[208:211], v[112:115]
    ds_read_b64_tr_b16 v[164:165], v225 offset:16384
    v_mfma_f32_16x16x32_bf16 v[116:119], v[196:199], v[212:215], v[116:119]
    ds_read_b64_tr_b16 v[166:167], v225 offset:17408
    v_mfma_f32_16x16x32_bf16 v[120:123], v[196:199], v[216:219], v[120:123]
    ds_read_b128 v[184:187], v232 offset:49152
    v_mfma_f32_16x16x32_bf16 v[124:127], v[196:199], v[220:223], v[124:127]
    ds_read_b64_tr_b16 v[168:169], v226 offset:16384
    v_mfma_f32_16x16x32_bf16 v[128:131], v[200:203], v[208:211], v[128:131]
    ds_read_b64_tr_b16 v[170:171], v226 offset:17408
    v_mfma_f32_16x16x32_bf16 v[132:135], v[200:203], v[212:215], v[132:135]
    ds_read_b128 v[188:191], v232 offset:51200
    v_mfma_f32_16x16x32_bf16 v[136:139], v[200:203], v[216:219], v[136:139]
    ds_read_b64_tr_b16 v[172:173], v227 offset:16384
    v_mfma_f32_16x16x32_bf16 v[140:143], v[200:203], v[220:223], v[140:143]
    ds_read_b64_tr_b16 v[174:175], v227 offset:17408
    v_mfma_f32_16x16x32_bf16 v[144:147], v[204:207], v[208:211], v[144:147]
    ds_read_b128 v[240:243], v234 offset:16384
    v_mfma_f32_16x16x32_bf16 v[148:151], v[204:207], v[212:215], v[148:151]
    v_mfma_f32_16x16x32_bf16 v[152:155], v[204:207], v[216:219], v[152:155]
    v_mfma_f32_16x16x32_bf16 v[156:159], v[204:207], v[220:223], v[156:159]
    v_mfma_f32_16x16x32_bf16 v[80:83], v[244:247], v[244:247], v[80:83]
    v_smfmac_f32_16x16x64_bf16 v[64:67], v[92:95], v[192:199], v91
    v_smfmac_f32_16x16x64_bf16 v[68:71], v[92:95], v[200:207], v91
    v_smfmac_f32_16x16x64_bf16 v[72:75], v[92:95], v[208:215], v91
    v_smfmac_f32_16x16x64_bf16 v[76:79], v[92:95], v[216:223], v91
    s_waitcnt lgkmcnt(0)
    s_cmp_lg_u32 s61, 5
    s_cbranch_scc1 XC_20
    ds_read_b64 v[16:17], v236 offset:16384
    ds_read_b64 v[18:19], v236 offset:18432
    ds_read_b64 v[20:21], v236 offset:49152
    ds_read_b64 v[22:23], v236 offset:51200
XC_20:
    v_mfma_f32_16x16x32_bf16 v[96:99], v[160:163], v[176:179], v[96:99]
    ds_read_b128 v[208:211], v233 offset:16384
    v_mfma_f32_16x16x32_bf16 v[100:103], v[160:163], v[180:183], v[100:103]
    ds_read_b64_tr_b16 v[192:193], v228 offset:16384
    v_mfma_f32_16x16x32_bf16 v[104:107], v[160:163], v[184:187], v[104:107]
    ds_read_b64_tr_b16 v[194:195], v228 offset:17408
    v_mfma_f32_16x16x32_bf16 v[108:111], v[160:163], v[188:191], v[108:111]
    ds_read_b128 v[212:215], v233 offset:18432
    v_mfma_f32_16x16x32_bf16 v[112:115], v[164:167], v[176:179], v[112:115]
    ds_read_b64_tr_b16 v[196:197], v229 offset:16384
    v_mfma_f32_16x16x32_bf16 v[116:119], v[164:167], v[180:183], v[116:119]
    ds_read_b64_tr_b16 v[198:199], v229 offset:17408
    v_mfma_f32_16x16x32_bf16 v[120:123], v[164:167], v[184:187], v[120:123]
    ds_read_b128 v[216:219], v233 offset:49152
    v_mfma_f32_16x16x32_bf16 v[124:127], v[164:167], v[188:191], v[124:127]
    ds_read_b64_tr_b16 v[200:201], v230 offset:16384
    v_mfma_f32_16x16x32_bf16 v[128:131], v[168:171], v[176:179], v[128:131]
    ds_read_b64_tr_b16 v[202:203], v230 offset:17408
    v_mfma_f32_16x16x32_bf16 v[132:135], v[168:171], v[180:183], v[132:135]
    ds_read_b128 v[220:223], v233 offset:51200
    v_mfma_f32_16x16x32_bf16 v[136:139], v[168:171], v[184:187], v[136:139]
    ds_read_b64_tr_b16 v[204:205], v231 offset:16384
    v_mfma_f32_16x16x32_bf16 v[140:143], v[168:171], v[188:191], v[140:143]
    ds_read_b64_tr_b16 v[206:207], v231 offset:17408
    v_mfma_f32_16x16x32_bf16 v[144:147], v[172:175], v[176:179], v[144:147]
    ds_read_b128 v[244:247], v235 offset:16384
    v_mfma_f32_16x16x32_bf16 v[148:151], v[172:175], v[180:183], v[148:151]
    v_mfma_f32_16x16x32_bf16 v[152:155], v[172:175], v[184:187], v[152:155]
    v_mfma_f32_16x16x32_bf16 v[156:159], v[172:175], v[188:191], v[156:159]
    v_mfma_f32_16x16x32_bf16 v[80:83], v[240:243], v[240:243], v[80:83]
    v_smfmac_f32_16x16x64_bf16 v[64:67], v[92:95], v[160:167], v91
    v_smfmac_f32_16x16x64_bf16 v[68:71], v[92:95], v[168:175], v91
    v_smfmac_f32_16x16x64_bf16 v[72:75], v[92:95], v[176:183], v91
    v_smfmac_f32_16x16x64_bf16 v[76:79], v[92:95], v[184:191], v91
    s_waitcnt lgkmcnt(0)
    s_barrier
    v_mfma_f32_16x16x32_bf16 v[96:99], v[192:195], v[208:211], v[96:99]
    ds_read_b128 v[176:179], v232 offset:0
    v_mfma_f32_16x16x32_bf16 v[100:103], v[192:195], v[212:215], v[100:103]
    ds_read_b64_tr_b16 v[160:161], v224 offset:0
    v_mfma_f32_16x16x32_bf16 v[104:107], v[192:195], v[216:219], v[104:107]
    ds_read_b64_tr_b16 v[162:163], v224 offset:1024
    v_mfma_f32_16x16x32_bf16 v[108:111], v[192:195], v[220:223], v[108:111]
    ds_read_b128 v[180:183], v232 offset:2048
    v_mfma_f32_16x16x32_bf16 v[112:115], v[196:199], v[208:211], v[112:115]
    ds_read_b64_tr_b16 v[164:165], v225 offset:0
    v_mfma_f32_16x16x32_bf16 v[116:119], v[196:199], v[212:215], v[116:119]
    ds_read_b64_tr_b16 v[166:167], v225 offset:1024
    v_mfma_f32_16x16x32_bf16 v[120:123], v[196:199], v[216:219], v[120:123]
    ds_read_b128 v[184:187], v232 offset:32768
    v_mfma_f32_16x16x32_bf16 v[124:127], v[196:199], v[220:223], v[124:127]
    ds_read_b64_tr_b16 v[168:169], v226 offset:0
    v_mfma_f32_16x16x32_bf16 v[128:131], v[200:203], v[208:211], v[128:131]
    ds_read_b64_tr_b16 v[170:171], v226 offset:1024
    v_mfma_f32_16x16x32_bf16 v[132:135], v[200:203], v[212:215], v[132:135]
    ds_read_b128 v[188:191], v232 offset:34816
    v_mfma_f32_16x16x32_bf16 v[136:139], v[200:203], v[216:219], v[136:139]
    ds_read_b64_tr_b16 v[172:173], v227 offset:0
    v_mfma_f32_16x16x32_bf16 v[140:143], v[200:203], v[220:223], v[140:143]
    ds_read_b64_tr_b16 v[174:175], v227 offset:1024
    v_mfma_f32_16x16x32_bf16 v[144:147], v[204:207], v[208:211], v[144:147]
    ds_read_b128 v[240:243], v234 offset:0
    v_mfma_f32_16x16x32_bf16 v[148:151], v[204:207], v[212:215], v[148:151]
    v_mfma_f32_16x16x32_bf16 v[152:155], v[204:207], v[216:219], v[152:155]
    v_mfma_f32_16x16x32_bf16 v[156:159], v[204:207], v[220:223], v[156:159]
    v_mfma_f32_16x16x32_bf16 v[80:83], v[244:247], v[244:247], v[80:83]
    v_smfmac_f32_16x16x64_bf16 v[64:67], v[92:95], v[192:199], v91
    v_smfmac_f32_16x16x64_bf16 v[68:71], v[92:95], v[200:207], v91
    v_smfmac_f32_16x16x64_bf16 v[72:75], v[92:95], v[208:215], v91
    v_smfmac_f32_16x16x64_bf16 v[76:79], v[92:95], v[216:223], v91
    s_waitcnt lgkmcnt(0)
    s_cmp_lg_u32 s61, 6
    s_cbranch_scc1 XC_21
    ds_read_b64 v[16:17], v236 offset:0
    ds_read_b64 v[18:19], v236 offset:2048
    ds_read_b64 v[20:21], v236 offset:32768
    ds_read_b64 v[22:23], v236 offset:34816
XC_21:
    v_mfma_f32_16x16x32_bf16 v[96:99], v[160:163], v[176:179], v[96:99]
    ds_read_b128 v[208:211], v233 offset:0
    v_mfma_f32_16x16x32_bf16 v[100:103], v[160:163], v[180:183], v[100:103]
    ds_read_b64_tr_b16 v[192:193], v228 offset:0
    v_mfma_f32_16x16x32_bf16 v[104:107], v[160:163], v[184:187], v[104:107]
    ds_read_b64_tr_b16 v[194:195], v228 offset:1024
    v_mfma_f32_16x16x32_bf16 v[108:111], v[160:163], v[188:191], v[108:111]
    ds_read_b128 v[212:215], v233 offset:2048
    v_mfma_f32_16x16x32_bf16 v[112:115], v[164:167], v[176:179], v[112:115]
    ds_read_b64_tr_b16 v[196:197], v229 offset:0
    v_mfma_f32_16x16x32_bf16 v[116:119], v[164:167], v[180:183], v[116:119]
    ds_read_b64_tr_b16 v[198:199], v229 offset:1024
    v_mfma_f32_16x16x32_bf16 v[120:123], v[164:167], v[184:187], v[120:123]
    ds_read_b128 v[216:219], v233 offset:32768
    v_mfma_f32_16x16x32_bf16 v[124:127], v[164:167], v[188:191], v[124:127]
    ds_read_b64_tr_b16 v[200:201], v230 offset:0
    v_mfma_f32_16x16x32_bf16 v[128:131], v[168:171], v[176:179], v[128:131]
    ds_read_b64_tr_b16 v[202:203], v230 offset:1024
    v_mfma_f32_16x16x32_bf16 v[132:135], v[168:171], v[180:183], v[132:135]
    ds_read_b128 v[220:223], v233 offset:34816
    v_mfma_f32_16x16x32_bf16 v[136:139], v[168:171], v[184:187], v[136:139]
    ds_read_b64_tr_b16 v[204:205], v231 offset:0
    v_mfma_f32_16x16x32_bf16 v[140:143], v[168:171], v[188:191], v[140:143]
    ds_read_b64_tr_b16 v[206:207], v231 offset:1024
    v_mfma_f32_16x16x32_bf16 v[144:147], v[172:175], v[176:179], v[144:147]
    ds_read_b128 v[244:247], v235 offset:0
    v_mfma_f32_16x16x32_bf16 v[148:151], v[172:175], v[180:183], v[148:151]
    v_mfma_f32_16x16x32_bf16 v[152:155], v[172:175], v[184:187], v[152:155]
    v_mfma_f32_16x16x32_bf16 v[156:159], v[172:175], v[188:191], v[156:159]
    v_mfma_f32_16x16x32_bf16 v[80:83], v[240:243], v[240:243], v[80:83]
    v_smfmac_f32_16x16x64_bf16 v[64:67], v[92:95], v[160:167], v91
    v_smfmac_f32_16x16x64_bf16 v[68:71], v[92:95], v[168:175], v91
    v_smfmac_f32_16x16x64_bf16 v[72:75], v[92:95], v[176:183], v91
    v_smfmac_f32_16x16x64_bf16 v[76:79], v[92:95], v[184:191], v91
    s_waitcnt lgkmcnt(0)
    v_mfma_f32_16x16x32_bf16 v[80:83], v[244:247], v[244:247], v[80:83]
    v_smfmac_f32_16x16x64_bf16 v[64:67], v[92:95], v[192:199], v91
    v_smfmac_f32_16x16x64_bf16 v[68:71], v[92:95], v[200:207], v91
    v_smfmac_f32_16x16x64_bf16 v[72:75], v[92:95], v[208:215], v91
    v_smfmac_f32_16x16x64_bf16 v[76:79], v[92:95], v[216:223], v91
    v_mfma_f32_16x16x32_bf16 v[96:99], v[192:195], v[208:211], v[96:99]
    s_nop 0
    s_nop 0
    v_mfma_f32_16x16x32_bf16 v[100:103], v[192:195], v[212:215], v[100:103]
    v_cndmask_b32 v4, v80, v81, s[36:37]
    v_cndmask_b32 v50, v82, v83, s[36:37]
    v_cndmask_b32 v50, v4, v50, s[38:39]
    v_mfma_f32_16x16x32_bf16 v[104:107], v[192:195], v[216:219], v[104:107]
    v_add_f32 v64, v64, v65
    v_and_b32 v65, 0xffff0000, v64
    v_mfma_f32_16x16x32_bf16 v[108:111], v[192:195], v[220:223], v[108:111]
    v_sub_f32 v64, v64, v65
    v_cvt_pk_bf16_f32 v64, v65, v64
    v_add_f32 v66, v66, v67
    v_mfma_f32_16x16x32_bf16 v[112:115], v[196:199], v[208:211], v[112:115]
    v_and_b32 v67, 0xffff0000, v66
    v_sub_f32 v66, v66, v67
    v_mfma_f32_16x16x32_bf16 v[116:119], v[196:199], v[212:215], v[116:119]
    v_cvt_pk_bf16_f32 v66, v67, v66
    v_add_f32 v68, v68, v69
    v_and_b32 v69, 0xffff0000, v68
    v_mfma_f32_16x16x32_bf16 v[120:123], v[196:199], v[216:219], v[120:123]
    v_sub_f32 v68, v68, v69
    v_cvt_pk_bf16_f32 v68, v69, v68
    v_mfma_f32_16x16x32_bf16 v[124:127], v[196:199], v[220:223], v[124:127]
    v_add_f32 v70, v70, v71
    v_and_b32 v71, 0xffff0000, v70
    v_sub_f32 v70, v70, v71
    v_mfma_f32_16x16x32_bf16 v[128:131], v[200:203], v[208:211], v[128:131]
    v_cvt_pk_bf16_f32 v70, v71, v70
    v_add_f32 v52, v72, v73
    v_mfma_f32_16x16x32_bf16 v[132:135], v[200:203], v[212:215], v[132:135]
    v_mul_f32 v72, s95, v52
    v_mov_b32 v73, 0
    v_cvt_pk_bf16_f32 v72, v72, v72
    v_mfma_f32_16x16x32_bf16 v[136:139], v[200:203], v[216:219], v[136:139]
    v_add_f32 v53, v74, v75
    v_mul_f32 v74, s95, v53
    v_mfma_f32_16x16x32_bf16 v[140:143], v[200:203], v[220:223], v[140:143]
    v_mov_b32 v75, 0
    v_cvt_pk_bf16_f32 v74, v74, v74
    v_add_f32 v54, v76, v77
    v_mfma_f32_16x16x32_bf16 v[144:147], v[204:207], v[208:211], v[144:147]
    v_mul_f32 v76, s95, v54
    v_mov_b32 v77, 0
    v_mfma_f32_16x16x32_bf16 v[148:151], v[204:207], v[212:215], v[148:151]
    v_cvt_pk_bf16_f32 v76, v76, v76
    v_add_f32 v55, v78, v79
    v_mul_f32 v78, s95, v55
    v_mfma_f32_16x16x32_bf16 v[152:155], v[204:207], v[216:219], v[152:155]
    v_mov_b32 v79, 0
    v_cvt_pk_bf16_f32 v78, v78, v78
    v_mfma_f32_16x16x32_bf16 v[156:159], v[204:207], v[220:223], v[156:159]
    s_waitcnt lgkmcnt(0)
    s_barrier
    v_mfma_f32_16x16x16_bf16 v[96:99], v[64:65], v[72:73], v[96:99]
    ds_read2_b32 v[160:161], v12 offset0:0 offset1:1
    v_mfma_f32_16x16x16_bf16 v[112:115], v[66:67], v[72:73], v[112:115]
    ds_read2_b32 v[162:163], v12 offset0:2 offset1:3
    v_mfma_f32_16x16x16_bf16 v[100:103], v[64:65], v[74:75], v[100:103]
    ds_read2_b32 v[164:165], v12 offset0:128 offset1:129
    v_mfma_f32_16x16x16_bf16 v[116:119], v[66:67], v[74:75], v[116:119]
    ds_read2_b32 v[166:167], v12 offset0:130 offset1:131
    v_mfma_f32_16x16x16_bf16 v[104:107], v[64:65], v[76:77], v[104:107]
    ds_read2_b32 v[168:169], v13 offset0:0 offset1:1
    v_mfma_f32_16x16x16_bf16 v[120:123], v[66:67], v[76:77], v[120:123]
    ds_read2_b32 v[170:171], v13 offset0:2 offset1:3
.p2align 3
    v_mfma_f32_16x16x16_bf16 v[108:111], v[64:65], v[78:79], v[108:111]
    v_cvt_pk_bf16_f32 v224, v96, v97
    v_cvt_pk_bf16_f32 v225, v98, v99
    v_mfma_f32_16x16x16_bf16 v[124:127], v[66:67], v[78:79], v[124:127]
    v_cvt_pk_bf16_f32 v226, v112, v113
    v_cvt_pk_bf16_f32 v227, v114, v115
    v_pk_max_i16 v224, v224, 0
    v_pk_max_i16 v225, v225, 0
    v_pk_max_i16 v226, v226, 0
    v_pk_max_i16 v227, v227, 0
    buffer_store_dwordx4 v[224:227], v7, s[56:59], s28 offen sc1
    ds_read2_b32 v[172:173], v13 offset0:128 offset1:129
    ds_read2_b32 v[174:175], v13 offset0:130 offset1:131
    ds_read2_b32 v[176:177], v14 offset0:0 offset1:1
    v_mfma_f32_16x16x16_bf16 v[128:131], v[68:69], v[72:73], v[128:131]
    v_cvt_pk_bf16_f32 v228, v100, v101
    v_cvt_pk_bf16_f32 v229, v102, v103
    v_mfma_f32_16x16x16_bf16 v[144:147], v[70:71], v[72:73], v[144:147]
    v_cvt_pk_bf16_f32 v230, v116, v117
    v_cvt_pk_bf16_f32 v231, v118, v119
    v_pk_max_i16 v228, v228, 0
    v_pk_max_i16 v229, v229, 0
    v_pk_max_i16 v230, v230, 0
    v_pk_max_i16 v231, v231, 0
    buffer_store_dwordx4 v[228:231], v7, s[56:59], s28 offen offset:1024 sc1
    ds_read2_b32 v[178:179], v14 offset0:2 offset1:3
    ds_read2_b32 v[180:181], v14 offset0:128 offset1:129
    ds_read2_b32 v[182:183], v14 offset0:130 offset1:131
    v_mfma_f32_16x16x16_bf16 v[132:135], v[68:69], v[74:75], v[132:135]
    v_cvt_pk_bf16_f32 v232, v104, v105
    v_cvt_pk_bf16_f32 v233, v106, v107
    v_mfma_f32_16x16x16_bf16 v[148:151], v[70:71], v[74:75], v[148:151]
    v_cvt_pk_bf16_f32 v234, v120, v121
    v_cvt_pk_bf16_f32 v235, v122, v123
    v_pk_max_i16 v232, v232, 0
    v_pk_max_i16 v233, v233, 0
    v_pk_max_i16 v234, v234, 0
    v_pk_max_i16 v235, v235, 0
    buffer_store_dwordx4 v[232:235], v7, s[56:59], s28 offen offset:2048 sc1
    ds_read2_b32 v[184:185], v15 offset0:0 offset1:1
    ds_read2_b32 v[186:187], v15 offset0:2 offset1:3
    v_mfma_f32_16x16x16_bf16 v[136:139], v[68:69], v[76:77], v[136:139]
    v_cvt_pk_bf16_f32 v236, v108, v109
    v_cvt_pk_bf16_f32 v237, v110, v111
    v_mfma_f32_16x16x16_bf16 v[152:155], v[70:71], v[76:77], v[152:155]
    v_cvt_pk_bf16_f32 v238, v124, v125
    v_cvt_pk_bf16_f32 v239, v126, v127
    v_pk_max_i16 v236, v236, 0
    v_pk_max_i16 v237, v237, 0
    v_pk_max_i16 v238, v238, 0
    v_pk_max_i16 v239, v239, 0
    buffer_store_dwordx4 v[236:239], v7, s[56:59], s28 offen offset:3072 sc1
    ds_read2_b32 v[188:189], v15 offset0:128 offset1:129
    ds_read2_b32 v[190:191], v15 offset0:130 offset1:131
    v_mfma_f32_16x16x16_bf16 v[140:143], v[68:69], v[78:79], v[140:143]
    v_cvt_pk_bf16_f32 v240, v128, v129
    v_cvt_pk_bf16_f32 v241, v130, v131
    v_mfma_f32_16x16x16_bf16 v[156:159], v[70:71], v[78:79], v[156:159]
    v_cvt_pk_bf16_f32 v242, v144, v145
    v_cvt_pk_bf16_f32 v243, v146, v147
    v_pk_max_i16 v240, v240, 0
    v_pk_max_i16 v241, v241, 0
    v_pk_max_i16 v242, v242, 0
    v_pk_max_i16 v243, v243, 0
    buffer_store_dwordx4 v[240:243], v7, s[56:59], s29 offen sc1
    ds_read_b128 v[192:195], v32 offset:3584
    ds_read_b128 v[196:199], v32 offset:3072
    v_cvt_pk_bf16_f32 v244, v132, v133
    v_cvt_pk_bf16_f32 v245, v134, v135
    v_cvt_pk_bf16_f32 v246, v148, v149
    v_cvt_pk_bf16_f32 v247, v150, v151
    v_pk_max_i16 v244, v244, 0
    v_pk_max_i16 v245, v245, 0
    v_pk_max_i16 v246, v246, 0
    v_pk_max_i16 v247, v247, 0
    buffer_store_dwordx4 v[244:247], v7, s[56:59], s29 offen offset:1024 sc1
    ds_read_b128 v[200:203], v32 offset:2560
    ds_read_b128 v[204:207], v32 offset:2048
    v_cvt_pk_bf16_f32 v248, v136, v137
    v_cvt_pk_bf16_f32 v249, v138, v139
    v_cvt_pk_bf16_f32 v250, v152, v153
    v_cvt_pk_bf16_f32 v251, v154, v155
    v_pk_max_i16 v248, v248, 0
    v_pk_max_i16 v249, v249, 0
    v_pk_max_i16 v250, v250, 0
    v_pk_max_i16 v251, v251, 0
    buffer_store_dwordx4 v[248:251], v7, s[56:59], s29 offen offset:2048 sc1
    ds_read_b128 v[208:211], v32 offset:1536
    ds_read_b128 v[212:215], v32 offset:1024
    v_cvt_pk_bf16_f32 v252, v140, v141
    v_cvt_pk_bf16_f32 v253, v142, v143
    v_cvt_pk_bf16_f32 v254, v156, v157
    v_cvt_pk_bf16_f32 v255, v158, v159
    v_pk_max_i16 v252, v252, 0
    v_pk_max_i16 v253, v253, 0
    v_pk_max_i16 v254, v254, 0
    v_pk_max_i16 v255, v255, 0
    buffer_store_dwordx4 v[252:255], v7, s[56:59], s29 offen offset:3072 sc1
    ds_read_b128 v[216:219], v32 offset:512
    ds_read_b128 v[220:223], v32 offset:0
    s_waitcnt lgkmcnt(0)
    s_mov_b32 s85, 0
    v_mfma_f32_16x16x32_bf16 v[64:67], v[8:11], v[192:195], 0
    ds_write_b128 v49, v[224:227] offset:0
    v_mfma_f32_16x16x32_bf16 v[68:71], v[8:11], v[196:199], 0
    ds_write_b128 v49, v[228:231] offset:1024
    v_mfma_f32_16x16x32_bf16 v[72:75], v[8:11], v[200:203], 0
    ds_write_b128 v49, v[232:235] offset:2048
    v_mfma_f32_16x16x32_bf16 v[76:79], v[8:11], v[204:207], 0
    ds_write_b128 v49, v[236:239] offset:3072
    v_mfma_f32_16x16x32_bf16 v[80:83], v[8:11], v[208:211], 0
    ds_write_b128 v49, v[240:243] offset:32768
    v_mfma_f32_16x16x32_bf16 v[84:87], v[8:11], v[212:215], 0
    ds_write_b128 v49, v[244:247] offset:33792
    v_mfma_f32_16x16x32_bf16 v[88:91], v[8:11], v[216:219], 0
    ds_write_b128 v49, v[248:251] offset:34816
    v_mfma_f32_16x16x32_bf16 v[92:95], v[8:11], v[220:223], 0
    ds_write_b128 v49, v[252:255] offset:35840
    v_mfma_f32_16x16x32_bf16 v[64:67], v[160:163], v[192:195], v[64:67]
    ds_read_b128 v[128:131], v32 offset:3648
    v_mfma_f32_16x16x32_bf16 v[68:71], v[160:163], v[196:199], v[68:71]
    ds_read_b128 v[132:135], v32 offset:3136
    v_mfma_f32_16x16x32_bf16 v[72:75], v[160:163], v[200:203], v[72:75]
    s_bfm_b64 exec, 16, 0
    ds_write_b128 v51, v[52:55]
    s_mov_b64 exec, s[34:35]
    ds_write_b32 v56, v50
    s_mov_b64 exec, -1
    ds_write_b32 v38, v30 offset:32
    v_mfma_f32_16x16x32_bf16 v[76:79], v[160:163], v[204:207], v[76:79]
    ds_read_b128 v[136:139], v32 offset:2624
    v_mfma_f32_16x16x32_bf16 v[80:83], v[160:163], v[208:211], v[80:83]
    ds_read_b128 v[140:143], v32 offset:2112
    v_mfma_f32_16x16x32_bf16 v[84:87], v[160:163], v[212:215], v[84:87]
    s_getreg_b32 s80, hwreg(HW_REG_IB_STS, 0, 4)
    s_cmp_lg_u32 s80, s85
    s_cbranch_scc1 HK_22
    s_waitcnt vmcnt(0)
    s_bfm_b64 exec, 16, 0
    buffer_store_dword v29, v41, s[56:59], s86 offen sc1
    s_mov_b64 exec, -1
    ds_write_b32 v38, v30 offset:64
    s_mov_b32 s85, 64
HK_22:
    v_mfma_f32_16x16x32_bf16 v[88:91], v[160:163], v[216:219], v[88:91]
    ds_read_b128 v[144:147], v32 offset:1600
    v_mfma_f32_16x16x32_bf16 v[92:95], v[160:163], v[220:223], v[92:95]
    ds_read_b128 v[148:151], v32 offset:1088
    v_mfma_f32_16x16x32_bf16 v[68:71], v[164:167], v[192:195], v[68:71]
    v_mfma_f32_16x16x32_bf16 v[72:75], v[164:167], v[196:199], v[72:75]
    ds_read_b128 v[152:155], v32 offset:576
    v_mfma_f32_16x16x32_bf16 v[76:79], v[164:167], v[200:203], v[76:79]
    ds_read_b128 v[156:159], v32 offset:64
    v_mfma_f32_16x16x32_bf16 v[80:83], v[164:167], v[204:207], v[80:83]
    v_mfma_f32_16x16x32_bf16 v[84:87], v[164:167], v[208:211], v[84:87]
    ds_read2_b32 v[96:97], v12 offset0:16 offset1:17
    v_mfma_f32_16x16x32_bf16 v[88:91], v[164:167], v[212:215], v[88:91]
    ds_read2_b32 v[98:99], v12 offset0:18 offset1:19
    v_mfma_f32_16x16x32_bf16 v[92:95], v[164:167], v[216:219], v[92:95]
    s_getreg_b32 s80, hwreg(HW_REG_IB_STS, 0, 4)
    s_cmp_lg_u32 s80, s85
    s_cbranch_scc1 HK_23
    s_waitcnt vmcnt(0)
    s_bfm_b64 exec, 16, 0
    buffer_store_dword v29, v41, s[56:59], s86 offen sc1
    s_mov_b64 exec, -1
    ds_write_b32 v38, v30 offset:64
    s_mov_b32 s85, 64
HK_23:
    v_mfma_f32_16x16x32_bf16 v[72:75], v[168:171], v[192:195], v[72:75]
    ds_read2_b32 v[100:101], v12 offset0:144 offset1:145
    v_mfma_f32_16x16x32_bf16 v[76:79], v[168:171], v[196:199], v[76:79]
    ds_read2_b32 v[102:103], v12 offset0:146 offset1:147
    v_mfma_f32_16x16x32_bf16 v[80:83], v[168:171], v[200:203], v[80:83]
    v_mfma_f32_16x16x32_bf16 v[84:87], v[168:171], v[204:207], v[84:87]
    ds_read2_b32 v[104:105], v13 offset0:16 offset1:17
    v_mfma_f32_16x16x32_bf16 v[88:91], v[168:171], v[208:211], v[88:91]
    ds_read2_b32 v[106:107], v13 offset0:18 offset1:19
    v_mfma_f32_16x16x32_bf16 v[92:95], v[168:171], v[212:215], v[92:95]
    s_waitcnt lgkmcnt(8)
    v_mfma_f32_16x16x32_bf16 v[76:79], v[172:175], v[192:195], v[76:79]
    ds_read2_b32 v[108:109], v13 offset0:144 offset1:145
    v_mfma_f32_16x16x32_bf16 v[80:83], v[172:175], v[196:199], v[80:83]
    ds_read2_b32 v[110:111], v13 offset0:146 offset1:147
    v_mfma_f32_16x16x32_bf16 v[84:87], v[172:175], v[200:203], v[84:87]
    s_getreg_b32 s80, hwreg(HW_REG_IB_STS, 0, 4)
    s_cmp_lg_u32 s80, s85
    s_cbranch_scc1 HK_24
    s_waitcnt vmcnt(0)
    s_bfm_b64 exec, 16, 0
    buffer_store_dword v29, v41, s[56:59], s86 offen sc1
    s_mov_b64 exec, -1
    ds_write_b32 v38, v30 offset:64
    s_mov_b32 s85, 64
HK_24:
    v_mfma_f32_16x16x32_bf16 v[88:91], v[172:175], v[204:207], v[88:91]
    ds_read2_b32 v[112:113], v14 offset0:16 offset1:17
    v_mfma_f32_16x16x32_bf16 v[92:95], v[172:175], v[208:211], v[92:95]
    ds_read2_b32 v[114:115], v14 offset0:18 offset1:19
    v_mfma_f32_16x16x32_bf16 v[80:83], v[176:179], v[192:195], v[80:83]
    v_mfma_f32_16x16x32_bf16 v[84:87], v[176:179], v[196:199], v[84:87]
    ds_read2_b32 v[116:117], v14 offset0:144 offset1:145
    v_mfma_f32_16x16x32_bf16 v[88:91], v[176:179], v[200:203], v[88:91]
    ds_read2_b32 v[118:119], v14 offset0:146 offset1:147
    v_mfma_f32_16x16x32_bf16 v[92:95], v[176:179], v[204:207], v[92:95]
    v_mfma_f32_16x16x32_bf16 v[84:87], v[180:183], v[192:195], v[84:87]
    ds_read2_b32 v[120:121], v15 offset0:16 offset1:17
    v_mfma_f32_16x16x32_bf16 v[88:91], v[180:183], v[196:199], v[88:91]
    ds_read2_b32 v[122:123], v15 offset0:18 offset1:19
    v_mfma_f32_16x16x32_bf16 v[92:95], v[180:183], v[200:203], v[92:95]
    s_getreg_b32 s80, hwreg(HW_REG_IB_STS, 0, 4)
    s_cmp_lg_u32 s80, s85
    s_cbranch_scc1 HK_25
    s_waitcnt vmcnt(0)
    s_bfm_b64 exec, 16, 0
    buffer_store_dword v29, v41, s[56:59], s86 offen sc1
    s_mov_b64 exec, -1
    ds_write_b32 v38, v30 offset:64
    s_mov_b32 s85, 64
HK_25:
    v_mfma_f32_16x16x32_bf16 v[88:91], v[184:187], v[192:195], v[88:91]
    ds_read2_b32 v[124:125], v15 offset0:144 offset1:145
    v_mfma_f32_16x16x32_bf16 v[92:95], v[184:187], v[196:199], v[92:95]
    ds_read2_b32 v[126:127], v15 offset0:146 offset1:147
    v_mfma_f32_16x16x32_bf16 v[92:95], v[188:191], v[192:195], v[92:95]
    s_waitcnt lgkmcnt(4)
    v_mfma_f32_16x16x32_bf16 v[64:67], v[96:99], v[128:131], v[64:67]
    ds_read_b128 v[192:195], v32 offset:3712
    v_mfma_f32_16x16x32_bf16 v[68:71], v[96:99], v[132:135], v[68:71]
    ds_read_b128 v[196:199], v32 offset:3200
    v_mfma_f32_16x16x32_bf16 v[72:75], v[96:99], v[136:139], v[72:75]
    v_mfma_f32_16x16x32_bf16 v[76:79], v[96:99], v[140:143], v[76:79]
    ds_read_b128 v[200:203], v32 offset:2688
    v_mfma_f32_16x16x32_bf16 v[80:83], v[96:99], v[144:147], v[80:83]
    ds_read_b128 v[204:207], v32 offset:2176
    v_mfma_f32_16x16x32_bf16 v[84:87], v[96:99], v[148:151], v[84:87]
    s_getreg_b32 s80, hwreg(HW_REG_IB_STS, 0, 4)
    s_cmp_lg_u32 s80, s85
    s_cbranch_scc1 HK_26
    s_waitcnt vmcnt(0)
    s_bfm_b64 exec, 16, 0
    buffer_store_dword v29, v41, s[56:59], s86 offen sc1
    s_mov_b64 exec, -1
    ds_write_b32 v38, v30 offset:64
    s_mov_b32 s85, 64
HK_26:
    v_mfma_f32_16x16x32_bf16 v[88:91], v[96:99], v[152:155], v[88:91]
    ds_read_b128 v[208:211], v32 offset:1664
    v_mfma_f32_16x16x32_bf16 v[92:95], v[96:99], v[156:159], v[92:95]
    ds_read_b128 v[212:215], v32 offset:1152
    v_mfma_f32_16x16x32_bf16 v[68:71], v[100:103], v[128:131], v[68:71]
    v_mfma_f32_16x16x32_bf16 v[72:75], v[100:103], v[132:135], v[72:75]
    ds_read_b128 v[216:219], v32 offset:640
    v_mfma_f32_16x16x32_bf16 v[76:79], v[100:103], v[136:139], v[76:79]
    ds_read_b128 v[220:223], v32 offset:128
    v_mfma_f32_16x16x32_bf16 v[80:83], v[100:103], v[140:143], v[80:83]
    v_mfma_f32_16x16x32_bf16 v[84:87], v[100:103], v[144:147], v[84:87]
    ds_read2_b32 v[160:161], v12 offset0:32 offset1:33
    v_mfma_f32_16x16x32_bf16 v[88:91], v[100:103], v[148:151], v[88:91]
    ds_read2_b32 v[162:163], v12 offset0:34 offset1:35
    v_mfma_f32_16x16x32_bf16 v[92:95], v[100:103], v[152:155], v[92:95]
    s_getreg_b32 s80, hwreg(HW_REG_IB_STS, 0, 4)
    s_cmp_lg_u32 s80, s85
    s_cbranch_scc1 HK_27
    s_waitcnt vmcnt(0)
    s_bfm_b64 exec, 16, 0
    buffer_store_dword v29, v41, s[56:59], s86 offen sc1
    s_mov_b64 exec, -1
    ds_write_b32 v38, v30 offset:64
    s_mov_b32 s85, 64
HK_27:
    v_mfma_f32_16x16x32_bf16 v[72:75], v[104:107], v[128:131], v[72:75]
    ds_read2_b32 v[164:165], v12 offset0:160 offset1:161
    v_mfma_f32_16x16x32_bf16 v[76:79], v[104:107], v[132:135], v[76:79]
    ds_read2_b32 v[166:167], v12 offset0:162 offset1:163
    v_mfma_f32_16x16x32_bf16 v[80:83], v[104:107], v[136:139], v[80:83]
    v_mfma_f32_16x16x32_bf16 v[84:87], v[104:107], v[140:143], v[84:87]
    ds_read2_b32 v[168:169], v13 offset0:32 offset1:33
    v_mfma_f32_16x16x32_bf16 v[88:91], v[104:107], v[144:147], v[88:91]
    ds_read2_b32 v[170:171], v13 offset0:34 offset1:35
    v_mfma_f32_16x16x32_bf16 v[92:95], v[104:107], v[148:151], v[92:95]
    s_waitcnt lgkmcnt(8)
    v_mfma_f32_16x16x32_bf16 v[76:79], v[108:111], v[128:131], v[76:79]
    ds_read2_b32 v[172:173], v13 offset0:160 offset1:161
    v_mfma_f32_16x16x32_bf16 v[80:83], v[108:111], v[132:135], v[80:83]
    ds_read2_b32 v[174:175], v13 offset0:162 offset1:163
    v_mfma_f32_16x16x32_bf16 v[84:87], v[108:111], v[136:139], v[84:87]
    s_getreg_b32 s80, hwreg(HW_REG_IB_STS, 0, 4)
    s_cmp_lg_u32 s80, s85
    s_cbranch_scc1 HK_28
    s_waitcnt vmcnt(0)
    s_bfm_b64 exec, 16, 0
    buffer_store_dword v29, v41, s[56:59], s86 offen sc1
    s_mov_b64 exec, -1
    ds_write_b32 v38, v30 offset:64
    s_mov_b32 s85, 64
HK_28:
    v_mfma_f32_16x16x32_bf16 v[88:91], v[108:111], v[140:143], v[88:91]
    ds_read2_b32 v[176:177], v14 offset0:32 offset1:33
    v_mfma_f32_16x16x32_bf16 v[92:95], v[108:111], v[144:147], v[92:95]
    ds_read2_b32 v[178:179], v14 offset0:34 offset1:35
    v_mfma_f32_16x16x32_bf16 v[80:83], v[112:115], v[128:131], v[80:83]
    v_mfma_f32_16x16x32_bf16 v[84:87], v[112:115], v[132:135], v[84:87]
    ds_read2_b32 v[180:181], v14 offset0:160 offset1:161
    v_mfma_f32_16x16x32_bf16 v[88:91], v[112:115], v[136:139], v[88:91]
    ds_read2_b32 v[182:183], v14 offset0:162 offset1:163
    v_mfma_f32_16x16x32_bf16 v[92:95], v[112:115], v[140:143], v[92:95]
    v_mfma_f32_16x16x32_bf16 v[84:87], v[116:119], v[128:131], v[84:87]
    ds_read2_b32 v[184:185], v15 offset0:32 offset1:33
    v_mfma_f32_16x16x32_bf16 v[88:91], v[116:119], v[132:135], v[88:91]
    ds_read2_b32 v[186:187], v15 offset0:34 offset1:35
    v_mfma_f32_16x16x32_bf16 v[92:95], v[116:119], v[136:139], v[92:95]
    s_getreg_b32 s80, hwreg(HW_REG_IB_STS, 0, 4)
    s_cmp_lg_u32 s80, s85
    s_cbranch_scc1 HK_29
    s_waitcnt vmcnt(0)
    s_bfm_b64 exec, 16, 0
    buffer_store_dword v29, v41, s[56:59], s86 offen sc1
    s_mov_b64 exec, -1
    ds_write_b32 v38, v30 offset:64
    s_mov_b32 s85, 64
HK_29:
    v_mfma_f32_16x16x32_bf16 v[88:91], v[120:123], v[128:131], v[88:91]
    ds_read2_b32 v[188:189], v15 offset0:160 offset1:161
    v_mfma_f32_16x16x32_bf16 v[92:95], v[120:123], v[132:135], v[92:95]
    ds_read2_b32 v[190:191], v15 offset0:162 offset1:163
    v_mfma_f32_16x16x32_bf16 v[92:95], v[124:127], v[128:131], v[92:95]
    s_waitcnt lgkmcnt(4)
    v_mfma_f32_16x16x32_bf16 v[64:67], v[160:163], v[192:195], v[64:67]
    ds_read_b128 v[128:131], v32 offset:3776
    v_mfma_f32_16x16x32_bf16 v[68:71], v[160:163], v[196:199], v[68:71]
    ds_read_b128 v[132:135], v32 offset:3264
    v_mfma_f32_16x16x32_bf16 v[72:75], v[160:163], v[200:203], v[72:75]
    ds_read_b32 v5, v39 offset:80
    v_mfma_f32_16x16x32_bf16 v[76:79], v[160:163], v[204:207], v[76:79]
    ds_read_b128 v[136:139], v32 offset:2752
    v_mfma_f32_16x16x32_bf16 v[80:83], v[160:163], v[208:211], v[80:83]
    ds_read_b128 v[140:143], v32 offset:2240
    v_mfma_f32_16x16x32_bf16 v[84:87], v[160:163], v[212:215], v[84:87]
    s_cmp_lg_u32 s85, 0
    s_cbranch_scc1 HK_30
    s_waitcnt vmcnt(0)
    s_bfm_b64 exec, 16, 0
    buffer_store_dword v29, v41, s[56:59], s86 offen sc1
    s_mov_b64 exec, -1
    ds_write_b32 v38, v30 offset:64
    s_mov_b32 s85, 64
HK_30:
    v_mfma_f32_16x16x32_bf16 v[88:91], v[160:163], v[216:219], v[88:91]
    ds_read_b128 v[144:147], v32 offset:1728
    v_mfma_f32_16x16x32_bf16 v[92:95], v[160:163], v[220:223], v[92:95]
    ds_read_b128 v[148:151], v32 offset:1216
    v_mfma_f32_16x16x32_bf16 v[68:71], v[164:167], v[192:195], v[68:71]
    v_mfma_f32_16x16x32_bf16 v[72:75], v[164:167], v[196:199], v[72:75]
    ds_read_b128 v[152:155], v32 offset:704
    v_mfma_f32_16x16x32_bf16 v[76:79], v[164:167], v[200:203], v[76:79]
    ds_read_b128 v[156:159], v32 offset:192
    v_mfma_f32_16x16x32_bf16 v[80:83], v[164:167], v[204:207], v[80:83]
    v_mfma_f32_16x16x32_bf16 v[84:87], v[164:167], v[208:211], v[84:87]
    ds_read2_b32 v[96:97], v12 offset0:48 offset1:49
    v_mfma_f32_16x16x32_bf16 v[88:91], v[164:167], v[212:215], v[88:91]
    ds_read2_b32 v[98:99], v12 offset0:50 offset1:51
    v_mfma_f32_16x16x32_bf16 v[92:95], v[164:167], v[216:219], v[92:95]
    v_mfma_f32_16x16x32_bf16 v[72:75], v[168:171], v[192:195], v[72:75]
    ds_read2_b32 v[100:101], v12 offset0:176 offset1:177
    v_mfma_f32_16x16x32_bf16 v[76:79], v[168:171], v[196:199], v[76:79]
    ds_read2_b32 v[102:103], v12 offset0:178 offset1:179
    v_mfma_f32_16x16x32_bf16 v[80:83], v[168:171], v[200:203], v[80:83]
    v_mfma_f32_16x16x32_bf16 v[84:87], v[168:171], v[204:207], v[84:87]
    ds_read2_b32 v[104:105], v13 offset0:48 offset1:49
    v_mfma_f32_16x16x32_bf16 v[88:91], v[168:171], v[208:211], v[88:91]
    ds_read2_b32 v[106:107], v13 offset0:50 offset1:51
    v_mfma_f32_16x16x32_bf16 v[92:95], v[168:171], v[212:215], v[92:95]
    s_waitcnt lgkmcnt(8)
    v_mfma_f32_16x16x32_bf16 v[76:79], v[172:175], v[192:195], v[76:79]
    ds_read2_b32 v[108:109], v13 offset0:176 offset1:177
    v_mfma_f32_16x16x32_bf16 v[80:83], v[172:175], v[196:199], v[80:83]
    ds_read2_b32 v[110:111], v13 offset0:178 offset1:179
    v_mfma_f32_16x16x32_bf16 v[84:87], v[172:175], v[200:203], v[84:87]
    v_mfma_f32_16x16x32_bf16 v[88:91], v[172:175], v[204:207], v[88:91]
    ds_read2_b32 v[112:113], v14 offset0:48 offset1:49
    v_mfma_f32_16x16x32_bf16 v[92:95], v[172:175], v[208:211], v[92:95]
    ds_read2_b32 v[114:115], v14 offset0:50 offset1:51
    v_mfma_f32_16x16x32_bf16 v[80:83], v[176:179], v[192:195], v[80:83]
    v_mfma_f32_16x16x32_bf16 v[84:87], v[176:179], v[196:199], v[84:87]
    ds_read2_b32 v[116:117], v14 offset0:176 offset1:177
    v_mfma_f32_16x16x32_bf16 v[88:91], v[176:179], v[200:203], v[88:91]
    ds_read2_b32 v[118:119], v14 offset0:178 offset1:179
    v_mfma_f32_16x16x32_bf16 v[92:95], v[176:179], v[204:207], v[92:95]
    v_mfma_f32_16x16x32_bf16 v[84:87], v[180:183], v[192:195], v[84:87]
    ds_read2_b32 v[120:121], v15 offset0:48 offset1:49
    v_mfma_f32_16x16x32_bf16 v[88:91], v[180:183], v[196:199], v[88:91]
    ds_read2_b32 v[122:123], v15 offset0:50 offset1:51
    v_mfma_f32_16x16x32_bf16 v[92:95], v[180:183], v[200:203], v[92:95]
    v_mfma_f32_16x16x32_bf16 v[88:91], v[184:187], v[192:195], v[88:91]
    ds_read2_b32 v[124:125], v15 offset0:176 offset1:177
    v_mfma_f32_16x16x32_bf16 v[92:95], v[184:187], v[196:199], v[92:95]
    ds_read2_b32 v[126:127], v15 offset0:178 offset1:179
    v_mfma_f32_16x16x32_bf16 v[92:95], v[188:191], v[192:195], v[92:95]
    s_mov_b32 s83, 0
OB_33:
    v_cmp_eq_u32 vcc, 0, v5
    s_add_u32 s83, s83, 1
    s_cmp_gt_u32 s83, 800000
    s_cbranch_scc1 OBX_34
    s_cbranch_vccz OBX_34
    ds_read_b32 v5, v39 offset:80
    s_waitcnt lgkmcnt(0)
    s_branch OB_33
OBX_34:
    s_waitcnt lgkmcnt(4)
    s_cmp_eq_u32 s77, 0
    s_cbranch_scc1 RED_31
    v_mfma_f32_16x16x32_bf16 v[64:67], v[96:99], v[128:131], v[64:67]
    v_mfma_f32_16x16x32_bf16 v[68:71], v[96:99], v[132:135], v[68:71]
    v_mfma_f32_16x16x32_bf16 v[72:75], v[96:99], v[136:139], v[72:75]
    v_mfma_f32_16x16x32_bf16 v[76:79], v[96:99], v[140:143], v[76:79]
    v_mfma_f32_16x16x32_bf16 v[68:71], v[100:103], v[128:131], v[68:71]
    v_mfma_f32_16x16x32_bf16 v[72:75], v[100:103], v[132:135], v[72:75]
    v_mfma_f32_16x16x32_bf16 v[76:79], v[100:103], v[136:139], v[76:79]
    v_mfma_f32_16x16x32_bf16 v[72:75], v[104:107], v[128:131], v[72:75]
    v_mfma_f32_16x16x32_bf16 v[76:79], v[104:107], v[132:135], v[76:79]
    s_waitcnt lgkmcnt(0)
    v_mfma_f32_16x16x32_bf16 v[76:79], v[108:111], v[128:131], v[76:79]
    v_mfma_f32_16x16x32_bf16 v[80:83], v[96:99], v[144:147], v[80:83]
    v_mfma_f32_16x16x32_bf16 v[84:87], v[96:99], v[148:151], v[84:87]
    v_mfma_f32_16x16x32_bf16 v[88:91], v[96:99], v[152:155], v[88:91]
    v_mfma_f32_16x16x32_bf16 v[92:95], v[96:99], v[156:159], v[92:95]
    v_mfma_f32_16x16x32_bf16 v[80:83], v[100:103], v[140:143], v[80:83]
    v_mfma_f32_16x16x32_bf16 v[84:87], v[100:103], v[144:147], v[84:87]
    ds_write_b128 v33, v[64:67] offset:0
    v_mfma_f32_16x16x32_bf16 v[88:91], v[100:103], v[148:151], v[88:91]
    ds_write_b128 v33, v[68:71] offset:1024
    v_mfma_f32_16x16x32_bf16 v[92:95], v[100:103], v[152:155], v[92:95]
    ds_write_b128 v33, v[72:75] offset:2048
    v_mfma_f32_16x16x32_bf16 v[80:83], v[104:107], v[136:139], v[80:83]
    ds_write_b128 v33, v[76:79] offset:3072
    v_mfma_f32_16x16x32_bf16 v[84:87], v[104:107], v[140:143], v[84:87]
    s_mov_b64 exec, 1
    ds_add_u32 v36, v30 offset:0
    s_mov_b64 exec, -1
    v_mfma_f32_16x16x32_bf16 v[88:91], v[104:107], v[144:147], v[88:91]
    v_mfma_f32_16x16x32_bf16 v[92:95], v[104:107], v[148:151], v[92:95]
    v_mfma_f32_16x16x32_bf16 v[80:83], v[108:111], v[132:135], v[80:83]
    v_mfma_f32_16x16x32_bf16 v[84:87], v[108:111], v[136:139], v[84:87]
    v_mfma_f32_16x16x32_bf16 v[88:91], v[108:111], v[140:143], v[88:91]
    v_mfma_f32_16x16x32_bf16 v[92:95], v[108:111], v[144:147], v[92:95]
    v_mfma_f32_16x16x32_bf16 v[80:83], v[112:115], v[128:131], v[80:83]
    v_mfma_f32_16x16x32_bf16 v[84:87], v[112:115], v[132:135], v[84:87]
    v_mfma_f32_16x16x32_bf16 v[88:91], v[112:115], v[136:139], v[88:91]
    v_mfma_f32_16x16x32_bf16 v[92:95], v[112:115], v[140:143], v[92:95]
    v_mfma_f32_16x16x32_bf16 v[84:87], v[116:119], v[128:131], v[84:87]
    v_mfma_f32_16x16x32_bf16 v[88:91], v[116:119], v[132:135], v[88:91]
    v_mfma_f32_16x16x32_bf16 v[92:95], v[116:119], v[136:139], v[92:95]
    v_mfma_f32_16x16x32_bf16 v[88:91], v[120:123], v[128:131], v[88:91]
    v_mfma_f32_16x16x32_bf16 v[92:95], v[120:123], v[132:135], v[92:95]
    v_mfma_f32_16x16x32_bf16 v[92:95], v[124:127], v[128:131], v[92:95]
    s_mov_b32 s83, 0
LW_35:
    ds_read_b32 v5, v36 offset:0
    s_add_u32 s83, s83, 1
    s_waitcnt lgkmcnt(0)
    v_readfirstlane_b32 s82, v5
    s_cmp_gt_u32 s83, 800000
    s_cbranch_scc1 LWX_36
    s_cmp_ge_u32 s82, 2
    s_cbranch_scc1 LWX_36
    s_branch LW_35
LWX_36:
    ds_read_b128 v[160:163], v34 offset:0
    ds_read_b128 v[164:167], v34 offset:1024
    ds_read_b128 v[168:171], v34 offset:2048
    ds_read_b128 v[172:175], v34 offset:3072
    s_waitcnt lgkmcnt(3)
    v_add_f32 v160, v80, v160
    v_add_f32 v161, v81, v161
    v_add_f32 v162, v82, v162
    v_add_f32 v163, v83, v163
    s_waitcnt lgkmcnt(2)
    v_add_f32 v164, v84, v164
    v_add_f32 v165, v85, v165
    v_add_f32 v166, v86, v166
    v_add_f32 v167, v87, v167
    s_waitcnt lgkmcnt(1)
    v_add_f32 v168, v88, v168
    v_add_f32 v169, v89, v169
    v_add_f32 v170, v90, v170
    v_add_f32 v171, v91, v171
    s_waitcnt lgkmcnt(0)
    v_add_f32 v172, v92, v172
    v_add_f32 v173, v93, v173
    v_add_f32 v174, v94, v174
    v_add_f32 v175, v95, v175
    s_branch RED_32
RED_31:
    v_mfma_f32_16x16x32_bf16 v[80:83], v[96:99], v[144:147], v[80:83]
    v_mfma_f32_16x16x32_bf16 v[84:87], v[96:99], v[148:151], v[84:87]
    v_mfma_f32_16x16x32_bf16 v[88:91], v[96:99], v[152:155], v[88:91]
    v_mfma_f32_16x16x32_bf16 v[92:95], v[96:99], v[156:159], v[92:95]
    v_mfma_f32_16x16x32_bf16 v[80:83], v[100:103], v[140:143], v[80:83]
    v_mfma_f32_16x16x32_bf16 v[84:87], v[100:103], v[144:147], v[84:87]
    v_mfma_f32_16x16x32_bf16 v[88:91], v[100:103], v[148:151], v[88:91]
    v_mfma_f32_16x16x32_bf16 v[92:95], v[100:103], v[152:155], v[92:95]
    v_mfma_f32_16x16x32_bf16 v[80:83], v[104:107], v[136:139], v[80:83]
    s_waitcnt lgkmcnt(0)
    v_mfma_f32_16x16x32_bf16 v[84:87], v[104:107], v[140:143], v[84:87]
    v_mfma_f32_16x16x32_bf16 v[88:91], v[104:107], v[144:147], v[88:91]
    v_mfma_f32_16x16x32_bf16 v[92:95], v[104:107], v[148:151], v[92:95]
    v_mfma_f32_16x16x32_bf16 v[80:83], v[108:111], v[132:135], v[80:83]
    v_mfma_f32_16x16x32_bf16 v[84:87], v[108:111], v[136:139], v[84:87]
    v_mfma_f32_16x16x32_bf16 v[88:91], v[108:111], v[140:143], v[88:91]
    v_mfma_f32_16x16x32_bf16 v[92:95], v[108:111], v[144:147], v[92:95]
    v_mfma_f32_16x16x32_bf16 v[80:83], v[112:115], v[128:131], v[80:83]
    v_mfma_f32_16x16x32_bf16 v[84:87], v[112:115], v[132:135], v[84:87]
    v_mfma_f32_16x16x32_bf16 v[88:91], v[112:115], v[136:139], v[88:91]
    v_mfma_f32_16x16x32_bf16 v[92:95], v[112:115], v[140:143], v[92:95]
    v_mfma_f32_16x16x32_bf16 v[84:87], v[116:119], v[128:131], v[84:87]
    v_mfma_f32_16x16x32_bf16 v[88:91], v[116:119], v[132:135], v[88:91]
    v_mfma_f32_16x16x32_bf16 v[92:95], v[116:119], v[136:139], v[92:95]
    v_mfma_f32_16x16x32_bf16 v[88:91], v[120:123], v[128:131], v[88:91]
    v_mfma_f32_16x16x32_bf16 v[92:95], v[120:123], v[132:135], v[92:95]
    v_mfma_f32_16x16x32_bf16 v[92:95], v[124:127], v[128:131], v[92:95]
    v_mfma_f32_16x16x32_bf16 v[64:67], v[96:99], v[128:131], v[64:67]
    v_mfma_f32_16x16x32_bf16 v[68:71], v[96:99], v[132:135], v[68:71]
    v_mfma_f32_16x16x32_bf16 v[72:75], v[96:99], v[136:139], v[72:75]
    v_mfma_f32_16x16x32_bf16 v[76:79], v[96:99], v[140:143], v[76:79]
    v_mfma_f32_16x16x32_bf16 v[68:71], v[100:103], v[128:131], v[68:71]
    v_mfma_f32_16x16x32_bf16 v[72:75], v[100:103], v[132:135], v[72:75]
    ds_write_b128 v33, v[80:83] offset:0
    v_mfma_f32_16x16x32_bf16 v[76:79], v[100:103], v[136:139], v[76:79]
    ds_write_b128 v33, v[84:87] offset:1024
    v_mfma_f32_16x16x32_bf16 v[72:75], v[104:107], v[128:131], v[72:75]
    ds_write_b128 v33, v[88:91] offset:2048
    v_mfma_f32_16x16x32_bf16 v[76:79], v[104:107], v[132:135], v[76:79]
    ds_write_b128 v33, v[92:95] offset:3072
    v_mfma_f32_16x16x32_bf16 v[76:79], v[108:111], v[128:131], v[76:79]
    s_mov_b64 exec, 1
    ds_add_u32 v36, v30 offset:0
    s_mov_b64 exec, -1
    s_mov_b32 s83, 0
LW_37:
    ds_read_b32 v5, v36 offset:0
    s_add_u32 s83, s83, 1
    s_waitcnt lgkmcnt(0)
    v_readfirstlane_b32 s82, v5
    s_cmp_gt_u32 s83, 800000
    s_cbranch_scc1 LWX_38
    s_cmp_ge_u32 s82, 2
    s_cbranch_scc1 LWX_38
    s_branch LW_37
LWX_38:
    ds_read_b128 v[160:163], v34 offset:0
    ds_read_b128 v[164:167], v34 offset:1024
    ds_read_b128 v[168:171], v34 offset:2048
    ds_read_b128 v[172:175], v34 offset:3072
    s_waitcnt lgkmcnt(3)
    v_add_f32 v160, v64, v160
    v_add_f32 v161, v65, v161
    v_add_f32 v162, v66, v162
    v_add_f32 v163, v67, v163
    s_waitcnt lgkmcnt(2)
    v_add_f32 v164, v68, v164
    v_add_f32 v165, v69, v165
    v_add_f32 v166, v70, v166
    v_add_f32 v167, v71, v167
    s_waitcnt lgkmcnt(1)
    v_add_f32 v168, v72, v168
    v_add_f32 v169, v73, v169
    v_add_f32 v170, v74, v170
    v_add_f32 v171, v75, v171
    s_waitcnt lgkmcnt(0)
    v_add_f32 v172, v76, v172
    v_add_f32 v173, v77, v173
    v_add_f32 v174, v78, v174
    v_add_f32 v175, v79, v175
RED_32:
    v_cvt_pk_bf16_f32 v176, v160, v161
    v_cvt_pk_bf16_f32 v177, v162, v163
    ds_write_b64 v35, v[176:177] offset:0
    v_cvt_pk_bf16_f32 v178, v164, v165
    v_cvt_pk_bf16_f32 v179, v166, v167
    ds_write_b64 v35, v[178:179] offset:512
    v_cvt_pk_bf16_f32 v180, v168, v169
    v_cvt_pk_bf16_f32 v181, v170, v171
    ds_write_b64 v35, v[180:181] offset:1024
    v_cvt_pk_bf16_f32 v182, v172, v173
    v_cvt_pk_bf16_f32 v183, v174, v175
    ds_write_b64 v35, v[182:183] offset:1536
    ds_read_b128 v[184:187], v34
    ds_read_b128 v[188:191], v34 offset:1024
    ds_read_b32 v3, v46
    ds_read_b32 v4, v47
    ds_write_b32 v38, v30 offset:16
    s_waitcnt lgkmcnt(3)
    buffer_store_dwordx4 v[184:187], v48, s[56:59], s87 offen sc1
    buffer_store_dwordx4 v[188:191], v48, s[56:59], s87 offen offset:1024 sc1
    s_waitcnt lgkmcnt(0)
    v_mul_f32 v3, -s95, v3
    v_mul_f32 v4, -s95, v4
    v_fma_f32 v4, -v3, v3, v4
    v_max_f32 v4, 0, v4
    v_cvt_pk_bf16_f32 v3, v3, v3
    v_and_b32 v3, 0xffff0000, v3
    v_cvt_pk_bf16_f32 v4, v4, v4
    v_and_b32 v4, 0xffff0000, v4
    v_add_f32 v4, 0x3727c5ac, v4
    v_cvt_pk_bf16_f32 v4, v4, v4
    v_and_b32 v4, 0xffff0000, v4
    v_sqrt_f32 v4, v4
    s_nop 0
    v_cvt_pk_bf16_f32 v4, v4, v4
    v_and_b32 v4, 0xffff0000, v4
    v_rcp_f32 v4, v4
    s_nop 1
    v_mov_b32_dpp v8, v3 quad_perm:[0,0,0,0] row_mask:0xf bank_mask:0xf
    v_mov_b32_dpp v12, v4 quad_perm:[0,0,0,0] row_mask:0xf bank_mask:0xf
    v_mov_b32_dpp v9, v3 quad_perm:[1,1,1,1] row_mask:0xf bank_mask:0xf
    v_mov_b32_dpp v13, v4 quad_perm:[1,1,1,1] row_mask:0xf bank_mask:0xf
    v_mov_b32_dpp v10, v3 quad_perm:[2,2,2,2] row_mask:0xf bank_mask:0xf
    v_mov_b32_dpp v14, v4 quad_perm:[2,2,2,2] row_mask:0xf bank_mask:0xf
    v_mov_b32_dpp v11, v3 quad_perm:[3,3,3,3] row_mask:0xf bank_mask:0xf
    v_mov_b32_dpp v15, v4 quad_perm:[3,3,3,3] row_mask:0xf bank_mask:0xf
    v_lshlrev_b32 v208, 16, v16
    v_and_b32 v209, 0xffff0000, v16
    v_lshlrev_b32 v210, 16, v17
    v_and_b32 v211, 0xffff0000, v17
    v_lshlrev_b32 v212, 16, v18
    v_and_b32 v213, 0xffff0000, v18
    v_lshlrev_b32 v214, 16, v19
    v_and_b32 v215, 0xffff0000, v19
    v_lshlrev_b32 v216, 16, v20
    v_and_b32 v217, 0xffff0000, v20
    v_lshlrev_b32 v218, 16, v21
    v_and_b32 v219, 0xffff0000, v21
    v_lshlrev_b32 v220, 16, v22
    v_and_b32 v221, 0xffff0000, v22
    v_lshlrev_b32 v222, 16, v23
    v_and_b32 v223, 0xffff0000, v23
    v_sub_f32 v160, v208, v8
    v_mul_f32 v160, v160, v12
    v_sub_f32 v161, v209, v8
    v_mul_f32 v161, v161, v12
    v_sub_f32 v162, v210, v8
    v_mul_f32 v162, v162, v12
    v_sub_f32 v163, v211, v8
    v_mul_f32 v163, v163, v12
    v_sub_f32 v164, v212, v9
    v_mul_f32 v164, v164, v13
    v_sub_f32 v165, v213, v9
    v_mul_f32 v165, v165, v13
    v_sub_f32 v166, v214, v9
    v_mul_f32 v166, v166, v13
    v_sub_f32 v167, v215, v9
    v_mul_f32 v167, v167, v13
    v_sub_f32 v168, v216, v10
    v_mul_f32 v168, v168, v14
    v_sub_f32 v169, v217, v10
    v_mul_f32 v169, v169, v14
    v_sub_f32 v170, v218, v10
    v_mul_f32 v170, v170, v14
    v_sub_f32 v171, v219, v10
    v_mul_f32 v171, v171, v14
    v_sub_f32 v172, v220, v11
    v_mul_f32 v172, v172, v15
    v_sub_f32 v173, v221, v11
    v_mul_f32 v173, v173, v15
    v_sub_f32 v174, v222, v11
    v_mul_f32 v174, v174, v15
    v_sub_f32 v175, v223, v11
    v_mul_f32 v175, v175, v15
    v_mov_b32 v144, 0
    v_mov_b32 v145, 0
    v_mov_b32 v146, 0
    v_mov_b32 v147, 0
    v_mov_b32 v148, 0
    v_mov_b32 v149, 0
    v_mov_b32 v150, 0
    v_mov_b32 v151, 0
    v_mov_b32 v152, 0
    v_mov_b32 v153, 0
    v_mov_b32 v154, 0
    v_mov_b32 v155, 0
    v_mov_b32 v156, 0
    v_mov_b32 v157, 0
    v_mov_b32 v158, 0
    v_mov_b32 v159, 0
    s_waitcnt vmcnt(0)
    s_bfm_b64 exec, 16, 0
    buffer_store_dword v28, v41, s[56:59], s88 offen sc1
    s_mov_b64 exec, -1
    v_mov_b32 v67, v28
    v_mov_b32 v71, v28
    v_mov_b32 v75, v28
    v_mov_b32 v79, v28
    s_mov_b32 s83, 0
PW_41:
    ds_read_b32 v5, v39 offset:128
    s_add_u32 s83, s83, 1
    s_waitcnt lgkmcnt(0)
    v_cmp_eq_u32 vcc, 0, v5
    s_cmp_gt_u32 s83, 800000
    s_cbranch_scc1 PWX_42
    s_cbranch_vccz PWX_42
    s_sleep 1
    s_branch PW_41
PWX_42:
    ds_read_b128 v[192:195], v42 offset:0
    ds_read_b128 v[196:199], v42 offset:32768
    ds_read_b128 v[200:203], v43 offset:0
    ds_read_b128 v[204:207], v43 offset:32768
    s_waitcnt lgkmcnt(2)
    v_add_f32 v192, v192, v196
    v_add_f32 v193, v193, v197
    v_add_f32 v194, v194, v198
    v_add_f32 v195, v195, v199
    s_waitcnt lgkmcnt(0)
    v_add_f32 v200, v200, v204
    v_add_f32 v201, v201, v205
    v_add_f32 v202, v202, v206
    v_add_f32 v203, v203, v207
    v_add_f32 v192, v192, v200
    v_add_f32 v193, v193, v201
    v_add_f32 v194, v194, v202
    v_add_f32 v195, v195, v203
    v_perm_b32 v64, v193, v192, s44
    v_perm_b32 v65, v194, v193, s45
    v_perm_b32 v66, v195, v194, s46
    buffer_store_dwordx4 v[64:67], v7, s[56:59], s43 offen sc1
    s_mov_b32 s83, 0
PW_45:
    ds_read_b32 v5, v39 offset:144
    s_add_u32 s83, s83, 1
    s_waitcnt lgkmcnt(0)
    v_cmp_eq_u32 vcc, 0, v5
    s_cmp_gt_u32 s83, 800000
    s_cbranch_scc1 PWX_46
    s_cbranch_vccz PWX_46
    s_sleep 1
    s_branch PW_45
PWX_46:
    ds_read_b128 v[192:195], v42 offset:4096
    ds_read_b128 v[196:199], v42 offset:36864
    ds_read_b128 v[200:203], v43 offset:4096
    ds_read_b128 v[204:207], v43 offset:36864
    s_waitcnt lgkmcnt(2)
    v_add_f32 v192, v192, v196
    v_add_f32 v193, v193, v197
    v_add_f32 v194, v194, v198
    v_add_f32 v195, v195, v199
    s_waitcnt lgkmcnt(0)
    v_add_f32 v200, v200, v204
    v_add_f32 v201, v201, v205
    v_add_f32 v202, v202, v206
    v_add_f32 v203, v203, v207
    v_add_f32 v192, v192, v200
    v_add_f32 v193, v193, v201
    v_add_f32 v194, v194, v202
    v_add_f32 v195, v195, v203
    v_perm_b32 v68, v193, v192, s44
    v_perm_b32 v69, v194, v193, s45
    v_perm_b32 v70, v195, v194, s46
    buffer_store_dwordx4 v[68:71], v7, s[56:59], s43 offen offset:1024 sc1
    s_cmp_lg_u32 s60, 0
    s_cbranch_scc1 YQ_47
    buffer_load_dword v96, v40, s[56:59], s89 offen sc1
YQ_47:
    s_mov_b32 s83, 0
PW_50:
    ds_read_b32 v5, v39 offset:160
    s_add_u32 s83, s83, 1
    s_waitcnt lgkmcnt(0)
    v_cmp_eq_u32 vcc, 0, v5
    s_cmp_gt_u32 s83, 800000
    s_cbranch_scc1 PWX_51
    s_cbranch_vccz PWX_51
    s_sleep 1
    s_branch PW_50
PWX_51:
    ds_read_b128 v[192:195], v42 offset:8192
    ds_read_b128 v[196:199], v42 offset:40960
    ds_read_b128 v[200:203], v43 offset:8192
    ds_read_b128 v[204:207], v43 offset:40960
    s_waitcnt lgkmcnt(2)
    v_add_f32 v192, v192, v196
    v_add_f32 v193, v193, v197
    v_add_f32 v194, v194, v198
    v_add_f32 v195, v195, v199
    s_waitcnt lgkmcnt(0)
    v_add_f32 v200, v200, v204
    v_add_f32 v201, v201, v205
    v_add_f32 v202, v202, v206
    v_add_f32 v203, v203, v207
    v_add_f32 v192, v192, v200
    v_add_f32 v193, v193, v201
    v_add_f32 v194, v194, v202
    v_add_f32 v195, v195, v203
    v_perm_b32 v72, v193, v192, s44
    v_perm_b32 v73, v194, v193, s45
    v_perm_b32 v74, v195, v194, s46
    buffer_store_dwordx4 v[72:75], v7, s[56:59], s43 offen offset:2048 sc1
    s_mov_b32 s83, 0
PW_54:
    ds_read_b32 v5, v39 offset:176
    s_add_u32 s83, s83, 1
    s_waitcnt lgkmcnt(0)
    v_cmp_eq_u32 vcc, 0, v5
    s_cmp_gt_u32 s83, 800000
    s_cbranch_scc1 PWX_55
    s_cbranch_vccz PWX_55
    s_sleep 1
    s_branch PW_54
PWX_55:
    ds_read_b128 v[192:195], v42 offset:12288
    ds_read_b128 v[196:199], v42 offset:45056
    ds_read_b128 v[200:203], v43 offset:12288
    ds_read_b128 v[204:207], v43 offset:45056
    s_waitcnt lgkmcnt(2)
    v_add_f32 v192, v192, v196
    v_add_f32 v193, v193, v197
    v_add_f32 v194, v194, v198
    v_add_f32 v195, v195, v199
    s_waitcnt lgkmcnt(0)
    v_add_f32 v200, v200, v204
    v_add_f32 v201, v201, v205
    v_add_f32 v202, v202, v206
    v_add_f32 v203, v203, v207
    v_add_f32 v192, v192, v200
    v_add_f32 v193, v193, v201
    v_add_f32 v194, v194, v202
    v_add_f32 v195, v195, v203
    v_perm_b32 v76, v193, v192, s44
    v_perm_b32 v77, v194, v193, s45
    v_perm_b32 v78, v195, v194, s46
    buffer_store_dwordx4 v[76:79], v7, s[56:59], s43 offen offset:3072 sc1
    s_cmp_lg_u32 s60, 0
    s_cbranch_scc1 YP_56
    s_waitcnt vmcnt(2)
    v_cmp_ne_u32 vcc, s70, v96
    s_nop 1
    s_cbranch_vccz YP_57
    s_mov_b32 s83, 0
POLL_58:
    buffer_load_dword v5, v40, s[56:59], s89 offen sc1
    s_waitcnt vmcnt(0)
    v_cmp_ne_u32 vcc, s70, v5
    s_add_u32 s83, s83, 1
    s_cmp_gt_u32 s83, 100000
    s_cbranch_scc1 POLLX_59
    s_cbranch_vccz POLLX_59
    s_branch POLL_58
POLLX_59:
YP_57:
    ds_write_b32 v31, v30 offset:20
YP_56:
    s_mov_b32 s83, 0
LW_60:
    ds_read_b32 v5, v31 offset:20
    s_add_u32 s83, s83, 1
    s_waitcnt lgkmcnt(0)
    v_readfirstlane_b32 s82, v5
    s_cmp_gt_u32 s83, 800000
    s_cbranch_scc1 LWX_61
    s_cmp_ge_u32 s82, 1
    s_cbranch_scc1 LWX_61
    s_branch LW_60
LWX_61:
    buffer_load_dwordx4 v44, s[56:59], s90 offen sc1 lds
    buffer_load_dwordx4 v45, s[56:59], s90 offen offset:1024 sc1 lds
    s_cmp_lg_u32 s60, 1
    s_cbranch_scc1 EP_63
    s_cmp_lg_u32 s68, 0
    s_cbranch_scc1 EP_62
    s_bfm_b64 exec, 16, 0
    buffer_store_dword v28, v41, s[56:59], s72 offen
    s_mov_b64 exec, -1
EP_62:
    s_cmp_lg_u32 s61, 0
    s_cbranch_scc1 EP_63
    s_bfm_b64 exec, 16, 0
    buffer_store_dword v29, v41, s[56:59], s73 offen
    s_mov_b64 exec, -1
EP_63:
    s_mov_b32 s83, 0
PW_66:
    ds_read_b32 v5, v39 offset:192
    s_add_u32 s83, s83, 1
    s_waitcnt lgkmcnt(0)
    v_cmp_eq_u32 vcc, 0, v5
    s_cmp_gt_u32 s83, 800000
    s_cbranch_scc1 PWX_67
    s_cbranch_vccz PWX_67
    s_sleep 1
    s_branch PW_66
PWX_67:
    ds_read_b128 v[192:195], v42 offset:16384
    ds_read_b128 v[196:199], v42 offset:49152
    ds_read_b128 v[200:203], v43 offset:16384
    ds_read_b128 v[204:207], v43 offset:49152
    s_waitcnt lgkmcnt(2)
    v_add_f32 v192, v192, v196
    v_add_f32 v193, v193, v197
    v_add_f32 v194, v194, v198
    v_add_f32 v195, v195, v199
    s_waitcnt lgkmcnt(0)
    v_add_f32 v200, v200, v204
    v_add_f32 v201, v201, v205
    v_add_f32 v202, v202, v206
    v_add_f32 v203, v203, v207
    v_add_f32 v192, v192, v200
    v_add_f32 v193, v193, v201
    v_add_f32 v194, v194, v202
    v_add_f32 v195, v195, v203
    v_fmac_f32 v208, v192, v12
    v_fmac_f32 v209, v193, v12
    v_fmac_f32 v210, v194, v12
    v_fmac_f32 v211, v195, v12
    s_mov_b32 s83, 0
PW_70:
    ds_read_b32 v5, v39 offset:208
    s_add_u32 s83, s83, 1
    s_waitcnt lgkmcnt(0)
    v_cmp_eq_u32 vcc, 0, v5
    s_cmp_gt_u32 s83, 800000
    s_cbranch_scc1 PWX_71
    s_cbranch_vccz PWX_71
    s_sleep 1
    s_branch PW_70
PWX_71:
    ds_read_b128 v[192:195], v42 offset:24576
    ds_read_b128 v[196:199], v42 offset:57344
    ds_read_b128 v[200:203], v43 offset:24576
    ds_read_b128 v[204:207], v43 offset:57344
    s_waitcnt lgkmcnt(2)
    v_add_f32 v192, v192, v196
    v_add_f32 v193, v193, v197
    v_add_f32 v194, v194, v198
    v_add_f32 v195, v195, v199
    s_waitcnt lgkmcnt(0)
    v_add_f32 v200, v200, v204
    v_add_f32 v201, v201, v205
    v_add_f32 v202, v202, v206
    v_add_f32 v203, v203, v207
    v_add_f32 v192, v192, v200
    v_add_f32 v193, v193, v201
    v_add_f32 v194, v194, v202
    v_add_f32 v195, v195, v203
    v_fmac_f32 v212, v192, v13
    v_fmac_f32 v213, v193, v13
    v_fmac_f32 v214, v194, v13
    v_fmac_f32 v215, v195, v13
    buffer_load_dwordx4 v[80:83], v7, s[56:59], s42 offen sc1
    buffer_load_dwordx4 v[84:87], v7, s[56:59], s42 offen offset:1024 sc1
    buffer_load_dwordx4 v[88:91], v7, s[56:59], s42 offen offset:2048 sc1
    buffer_load_dwordx4 v[92:95], v7, s[56:59], s42 offen offset:3072 sc1
    s_waitcnt vmcnt(4)
    ds_write_b32 v38, v30
    s_mov_b32 s83, 0
PW_72:
    ds_read_b32 v5, v39 offset:32
    s_add_u32 s83, s83, 1
    s_waitcnt lgkmcnt(0)
    v_cmp_eq_u32 vcc, 0, v5
    s_cmp_gt_u32 s83, 800000
    s_cbranch_scc1 PWX_73
    s_cbranch_vccz PWX_73
    s_branch PW_72
PWX_73:
    ds_read_u16_d16_hi v144, v24 offset:0
    ds_read_u16_d16_hi v145, v24 offset:128
    ds_read_u16_d16_hi v146, v24 offset:256
    ds_read_u16_d16_hi v147, v24 offset:384
    ds_read_u16_d16_hi v148, v25 offset:0
    ds_read_u16_d16_hi v149, v25 offset:128
    ds_read_u16_d16_hi v150, v25 offset:256
    ds_read_u16_d16_hi v151, v25 offset:384
    ds_read_u16_d16_hi v152, v26 offset:0
    ds_read_u16_d16_hi v153, v26 offset:128
    ds_read_u16_d16_hi v154, v26 offset:256
    ds_read_u16_d16_hi v155, v26 offset:384
    ds_read_u16_d16_hi v156, v27 offset:0
    ds_read_u16_d16_hi v157, v27 offset:128
    ds_read_u16_d16_hi v158, v27 offset:256
    ds_read_u16_d16_hi v159, v27 offset:384
    s_waitcnt lgkmcnt(12)
    v_fmac_f32 v208, v160, v144
    v_fmac_f32 v209, v161, v145
    v_fmac_f32 v210, v162, v146
    v_fmac_f32 v211, v163, v147
    s_waitcnt lgkmcnt(8)
    v_fmac_f32 v212, v164, v148
    v_fmac_f32 v213, v165, v149
    v_fmac_f32 v214, v166, v150
    v_fmac_f32 v215, v167, v151
    s_waitcnt lgkmcnt(4)
    v_fmac_f32 v216, v168, v152
    v_fmac_f32 v217, v169, v153
    v_fmac_f32 v218, v170, v154
    v_fmac_f32 v219, v171, v155
    s_waitcnt lgkmcnt(0)
    v_fmac_f32 v220, v172, v156
    v_fmac_f32 v221, v173, v157
    v_fmac_f32 v222, v174, v158
    v_fmac_f32 v223, v175, v159
    s_mov_b32 s83, 0
PW_74:
    ds_read_b32 v5, v39 offset:224
    ds_read_b128 v[192:195], v42 offset:28672
    ds_read_b128 v[196:199], v42 offset:61440
    ds_read_b128 v[200:203], v43 offset:28672
    ds_read_b128 v[204:207], v43 offset:61440
    s_add_u32 s83, s83, 1
    s_waitcnt lgkmcnt(4)
    v_cmp_eq_u32 vcc, 0, v5
    s_cmp_gt_u32 s83, 800000
    s_cbranch_scc1 PWX_75
    s_cbranch_vccnz PW_74
PWX_75:
    s_waitcnt lgkmcnt(2)
    v_add_f32 v192, v192, v196
    v_add_f32 v193, v193, v197
    v_add_f32 v194, v194, v198
    v_add_f32 v195, v195, v199
    s_waitcnt lgkmcnt(0)
    v_add_f32 v200, v200, v204
    v_add_f32 v201, v201, v205
    v_add_f32 v202, v202, v206
    v_add_f32 v203, v203, v207
    v_add_f32 v192, v192, v200
    v_add_f32 v193, v193, v201
    v_add_f32 v194, v194, v202
    v_add_f32 v195, v195, v203
    v_fmac_f32 v216, v192, v14
    v_fmac_f32 v217, v193, v14
    v_fmac_f32 v218, v194, v14
    v_fmac_f32 v219, v195, v14
    s_waitcnt vmcnt(0)
    s_mov_b32 s83, 0
RC_76:
    v_min3_u32 v2, v83, v87, v91
    v_max3_u32 v3, v83, v87, v91
    v_min_u32 v2, v2, v95
    v_max_u32 v3, v3, v95
    v_xor_b32 v2, s70, v2
    v_xor_b32 v3, s70, v3
    v_or_b32 v2, v2, v3
    v_cmp_ne_u32 vcc, 0, v2
    s_add_u32 s83, s83, 1
    s_cmp_gt_u32 s83, 100000
    s_cbranch_vccz RCX_77
    s_cbranch_scc1 RCX_77
    buffer_load_dwordx4 v[80:83], v7, s[56:59], s42 offen sc1
    buffer_load_dwordx4 v[84:87], v7, s[56:59], s42 offen offset:1024 sc1
    buffer_load_dwordx4 v[88:91], v7, s[56:59], s42 offen offset:2048 sc1
    buffer_load_dwordx4 v[92:95], v7, s[56:59], s42 offen offset:3072 sc1
    s_waitcnt vmcnt(0)
    s_branch RC_76
RCX_77:
    v_perm_b32 v2, v80, v80, s47
    v_perm_b32 v3, v81, v80, s48
    v_perm_b32 v4, v82, v81, s49
    v_perm_b32 v83, v82, v82, s50
    v_fmac_f32 v208, v2, v12
    v_fmac_f32 v209, v3, v12
    v_fmac_f32 v210, v4, v12
    v_fmac_f32 v211, v83, v12
    v_perm_b32 v2, v84, v84, s47
    v_perm_b32 v3, v85, v84, s48
    v_perm_b32 v4, v86, v85, s49
    v_perm_b32 v87, v86, v86, s50
    v_fmac_f32 v212, v2, v13
    v_fmac_f32 v213, v3, v13
    v_fmac_f32 v214, v4, v13
    v_fmac_f32 v215, v87, v13
    v_perm_b32 v2, v88, v88, s47
    v_perm_b32 v3, v89, v88, s48
    v_perm_b32 v4, v90, v89, s49
    v_perm_b32 v91, v90, v90, s50
    v_fmac_f32 v216, v2, v14
    v_fmac_f32 v217, v3, v14
    v_fmac_f32 v218, v4, v14
    v_fmac_f32 v219, v91, v14
    v_perm_b32 v2, v92, v92, s47
    v_perm_b32 v3, v93, v92, s48
    v_perm_b32 v4, v94, v93, s49
    v_perm_b32 v95, v94, v94, s50
    v_fmac_f32 v220, v2, v15
    v_fmac_f32 v221, v3, v15
    v_fmac_f32 v222, v4, v15
    v_fmac_f32 v223, v95, v15
    v_cvt_pk_bf16_f32 v16, v208, v209
    v_cvt_pk_bf16_f32 v17, v210, v211
    buffer_store_dwordx2 v[16:17], v37, s[52:55], s96 offen
    v_cvt_pk_bf16_f32 v18, v212, v213
    v_cvt_pk_bf16_f32 v19, v214, v215
    buffer_store_dwordx2 v[18:19], v37, s[52:55], s97 offen
    v_cvt_pk_bf16_f32 v20, v216, v217
    v_cvt_pk_bf16_f32 v21, v218, v219
    buffer_store_dwordx2 v[20:21], v37, s[52:55], s98 offen
    s_mov_b32 s83, 0
PW_78:
    ds_read_b32 v5, v39 offset:240
    ds_read_b128 v[192:195], v42 offset:20480
    ds_read_b128 v[196:199], v42 offset:53248
    ds_read_b128 v[200:203], v43 offset:20480
    ds_read_b128 v[204:207], v43 offset:53248
    s_add_u32 s83, s83, 1
    s_waitcnt lgkmcnt(4)
    v_cmp_eq_u32 vcc, 0, v5
    s_cmp_gt_u32 s83, 800000
    s_cbranch_scc1 PWX_79
    s_cbranch_vccnz PW_78
PWX_79:
    s_waitcnt lgkmcnt(2)
    v_add_f32 v192, v192, v196
    v_add_f32 v193, v193, v197
    v_add_f32 v194, v194, v198
    v_add_f32 v195, v195, v199
    s_waitcnt lgkmcnt(0)
    v_add_f32 v200, v200, v204
    v_add_f32 v201, v201, v205
    v_add_f32 v202, v202, v206
    v_add_f32 v203, v203, v207
    v_add_f32 v192, v192, v200
    v_add_f32 v193, v193, v201
    v_add_f32 v194, v194, v202
    v_add_f32 v195, v195, v203
    v_fmac_f32 v220, v192, v15
    v_fmac_f32 v221, v193, v15
    v_fmac_f32 v222, v194, v15
    v_fmac_f32 v223, v195, v15
    v_cvt_pk_bf16_f32 v22, v220, v221
    v_cvt_pk_bf16_f32 v23, v222, v223
    buffer_store_dwordx2 v[22:23], v37, s[52:55], s99 offen
    s_endpgm
L_helper:
    s_sub_u32 s81, s81, 28
    v_lshlrev_b32 v2, 7, v1
    v_mul_u32_u24 v20, 896, v1
    v_mul_u32_u24 v22, 37, v1
    v_lshrrev_b32 v22, 9, v22
    v_mul_u32_u24 v22, 1792, v22
    v_add_u32 v22, v22, v2
    s_lshl2_add_u32 s86, s79, s81
    s_mul_i32 s86, s86, 57344
    s_mov_b32 s90, s86
    s_lshr_b32 s87, s79, 1
    s_lshl2_add_u32 s87, s87, s81
    s_mul_i32 s87, s87, 14336
    s_and_b32 s82, s79, 1
    s_mul_i32 s80, s82, 1792
    s_add_u32 s87, s87, s80
    s_lshl3_add_u32 s88, s83, s79
    s_lshl2_add_u32 s88, s88, s81
    s_lshl_b32 s88, s88, 13
    s_lshl2_add_u32 s89, s82, s81
    s_lshl3_add_u32 s89, s89, s83
    s_lshr_b32 s80, s79, 1
    s_lshl2_add_u32 s89, s89, s80
    s_mul_i32 s89, s89, 6272
    s_mov_b32 s30, 1835008
    s_mov_b32 s31, 0x20000
    s_mov_b32 s46, 1605632
    s_mov_b32 s47, 0x20000
    s_mov_b32 s42, 1835008
    s_mov_b32 s43, 0x20000
    s_mov_b32 s50, 1605632
    s_mov_b32 s51, 0x20000
    s_mov_b32 s34, 1835008
    s_mov_b32 s35, 0x20000
    s_mov_b32 s38, 1835008
    s_mov_b32 s39, 0x20000
    s_waitcnt lgkmcnt(0)
    s_mov_b32 s28, s4
    s_and_b32 s29, s5, 0xffff
    s_mov_b32 s44, s18
    s_and_b32 s45, s19, 0xffff
    s_cmp_lg_u32 s83, 0
    s_cbranch_scc1 HX_80
    s_add_u32 s80, s87, 229376
    s_bfm_b64 exec, 56, 0
    buffer_load_dword v31, v22, s[44:47], s80 offen
    s_mov_b64 exec, -1
HX_80:
    s_cmp_lg_u32 s83, 1
    s_cbranch_scc1 HX_81
    buffer_load_dword v32, v20, s[28:31], s86 offen offset:128
HX_81:
    s_cmp_lg_u32 s83, 2
    s_cbranch_scc1 HX_82
    s_add_u32 s80, s87, 458752
    s_bfm_b64 exec, 56, 0
    buffer_load_dword v33, v22, s[44:47], s80 offen
    s_mov_b64 exec, -1
HX_82:
    s_cmp_lg_u32 s83, 3
    s_cbranch_scc1 HX_83
    buffer_load_dword v34, v20, s[28:31], s86 offen offset:256
HX_83:
    s_barrier
    s_cmp_lg_u32 s83, 0
    s_cbranch_scc1 HX_84
    s_add_u32 s80, s87, 688128
    s_bfm_b64 exec, 56, 0
    buffer_load_dword v36, v22, s[44:47], s80 offen
    s_mov_b64 exec, -1
HX_84:
    s_cmp_lg_u32 s83, 1
    s_cbranch_scc1 HX_85
    buffer_load_dword v37, v20, s[28:31], s86 offen offset:384
HX_85:
    s_cmp_lg_u32 s83, 2
    s_cbranch_scc1 HX_86
    s_add_u32 s80, s87, 917504
    s_bfm_b64 exec, 56, 0
    buffer_load_dword v38, v22, s[44:47], s80 offen
    s_mov_b64 exec, -1
HX_86:
    s_cmp_lg_u32 s83, 3
    s_cbranch_scc1 HX_87
    buffer_load_dword v39, v20, s[28:31], s86 offen offset:512
HX_87:
    s_barrier
    s_mov_b32 s40, s12
    s_and_b32 s41, s13, 0xffff
    buffer_load_dword v41, v2, s[40:43], s88 offen
    s_barrier
    s_cmp_lg_u32 s83, 0
    s_cbranch_scc1 HX_88
    s_add_u32 s80, s87, 1146880
    s_bfm_b64 exec, 56, 0
    buffer_load_dword v43, v22, s[44:47], s80 offen
    s_mov_b64 exec, -1
HX_88:
    s_cmp_lg_u32 s83, 1
    s_cbranch_scc1 HX_89
    buffer_load_dword v44, v20, s[28:31], s86 offen offset:640
HX_89:
    s_cmp_lg_u32 s83, 2
    s_cbranch_scc1 HX_90
    s_add_u32 s80, s87, 1376256
    s_bfm_b64 exec, 56, 0
    buffer_load_dword v45, v22, s[44:47], s80 offen
    s_mov_b64 exec, -1
HX_90:
    s_cmp_lg_u32 s83, 3
    s_cbranch_scc1 HX_91
    buffer_load_dword v46, v20, s[28:31], s86 offen offset:768
HX_91:
    s_barrier
    s_mov_b32 s48, s20
    s_and_b32 s49, s21, 0xffff
    s_bfm_b64 exec, 49, 0
    buffer_load_dword v48, v2, s[48:51], s89 offen
    s_mov_b64 exec, -1
L_end:
    s_endpgm
.fill (24832 - (. - parallel_sum__ssm_conv_h3__dense_activation_relu__prompt_kernel))/4, 4, 0xbf810000
.section .rodata,"a"
.p2align 6
.amdhsa_kernel parallel_sum__ssm_conv_h3__dense_activation_relu__prompt_kernel
  .amdhsa_next_free_vgpr 256
  .amdhsa_next_free_sgpr 102
  .amdhsa_accum_offset 256
  .amdhsa_group_segment_fixed_size 0
  .amdhsa_kernarg_size 96
  .amdhsa_user_sgpr_count 2
  .amdhsa_user_sgpr_kernarg_segment_ptr 1
  .amdhsa_system_sgpr_workgroup_id_x 1
  .amdhsa_float_denorm_mode_32 3
.end_amdhsa_kernel
```
